```python
import torch

def _softmax(x, axis=-1):
    return torch.softmax(x, dim=axis)
def _gelu(x):
    return torch.nn.functional.gelu(x, approximate="tanh")
def _silu(x):
    return torch.nn.functional.silu(x)
def _sigmoid(x):
    return torch.sigmoid(x)
def _layernorm(x, axis=-1, eps=1e-5):
    m = x.mean(dim=axis, keepdim=True)
    v = x.var(dim=axis, keepdim=True, unbiased=False)
    return (x - m) / torch.sqrt(v + eps)
def _scatter_add(tgt, idx, src, axis=0):
    return tgt.clone().index_add_(axis, idx, src)
def _segment_sum(src, seg, n):
    out = torch.zeros((n,) + src.shape[1:], dtype=src.dtype)
    return out.index_add_(0, seg, src)
def _pad(x, pw):
    flat = tuple(v for pair in reversed(pw) for v in pair)
    return torch.nn.functional.pad(x, flat)

kernel_name = 'parallel_sum__ssm_conv_s4__glu_gated_swiglu__prompt'

def setup_inputs():

    _w = (lambda a: (lambda t: t.to(torch.bfloat16) if t.is_floating_point() else t)(torch.as_tensor(a)))
    def _A_setup():
        B, L, D, N = 1, 2048, 640, 192
        A_re = -(lambda _x: torch.exp(torch.as_tensor(_x)))((lambda *s: torch.randn(*s, dtype=torch.bfloat16) * 6.4)(D, N))
        A_im = torch.pi * (lambda *s: torch.randn(*s, dtype=torch.bfloat16) * 0.05)(D, N)
        B_re = (lambda *s: torch.randn(*s, dtype=torch.bfloat16) * 0.1)(D, N)
        B_im = (lambda *s: torch.randn(*s, dtype=torch.bfloat16) * 0.1)(D, N)
        C_re = (lambda *s: torch.randn(*s, dtype=torch.bfloat16) * 0.1)(D, N)
        C_im = (lambda *s: torch.randn(*s, dtype=torch.bfloat16) * 0.1)(D, N)
        log_dt = (lambda *s: torch.randn(*s, dtype=torch.bfloat16) * 0.05)(D) * 0.5 - 4.0
        Dskip = (lambda *s: torch.randn(*s, dtype=torch.bfloat16) * 0.05)(D)
        return {
            "u": _w((lambda *s: torch.randn(*s, dtype=torch.bfloat16) * 0.05)(B, L, D)),
            "A_re": _w(A_re),
            "A_im": _w(A_im),
            "B_re": _w(B_re),
            "B_im": _w(B_im),
            "C_re": _w(C_re),
            "C_im": _w(C_im),
            "log_dt": _w(log_dt),
            "Dskip": _w(Dskip),
        }
    _A_in = _A_setup()

    def _B_setup():
        B, S, D, F = 1, 2048, 640, 1536
        return {
            "x": _w((lambda *s: torch.randn(*s, dtype=torch.bfloat16) * 0.05)(B, S, D)),
            "w1": _w((lambda *s: torch.randn(*s, dtype=torch.bfloat16) * 0.4)(D, F) * (2.0 / D) ** 0.5),
            "w3": _w((lambda *s: torch.randn(*s, dtype=torch.bfloat16) * 0.4)(D, F) * (2.0 / D) ** 0.5),
            "w2": _w((lambda *s: torch.randn(*s, dtype=torch.bfloat16) * 0.4)(F, D) * (2.0 / F) ** 0.5),
        }
    _B_in = _B_setup()

    return {
        "A_u": _A_in["u"],
        "A_A_re": _A_in["A_re"],
        "A_A_im": _A_in["A_im"],
        "A_B_re": _A_in["B_re"],
        "A_B_im": _A_in["B_im"],
        "A_C_re": _A_in["C_re"],
        "A_C_im": _A_in["C_im"],
        "A_log_dt": _A_in["log_dt"],
        "A_Dskip": _A_in["Dskip"],
        "B_x": _B_in["x"],
        "B_w1": _B_in["w1"],
        "B_w3": _B_in["w3"],
        "B_w2": _B_in["w2"],
    }

def reference(A_u, A_A_re, A_A_im, A_B_re, A_B_im, A_C_re, A_C_im, A_log_dt, A_Dskip, B_x, B_w1, B_w3, B_w2):
    def _A_ref(u, A_re, A_im, B_re, B_im, C_re, C_im, log_dt, Dskip):
        Bsz, L, D = u.shape
        dt = torch.exp(log_dt)[:, None]
        A = A_re + 1j * A_im
        Bc = B_re + 1j * B_im
        Cc = C_re + 1j * C_im
        logdA = dt * A
        dB = dt * Bc
        l = (lambda x, dt: x.to(dt))(torch.arange(L), A_re.dtype)
        P = torch.exp(logdA[:, :, None] * l[None, None, :])
        K = torch.einsum("dn,dnl,dn->dl", Cc, P, dB).real
        L2 = 2 * L
        Kp = _pad(K, ((0, 0), (0, L)))
        up = (lambda x, *d: x.permute(*d))(u, 0, 2, 1)
        up = _pad(up, ((0, 0), (0, 0), (0, L)))
        Kf = (lambda x, axes=(-2,-1): torch.fft.rfft2(x.float(), dim=axes))(Kp[:, None, :], axes=(-2, -1))
        Uf = (lambda x, axes=(-2,-1): torch.fft.rfft2(x.float(), dim=axes))(up[:, :, None, :], axes=(-2, -1))
        Yf = Uf * Kf[None, :, :, :]
        y = (lambda x, s, axes=(-2,-1): torch.fft.irfft2(x, s=s, dim=axes).to(torch.bfloat16))(Yf, (1, L2), axes=(-2, -1))[:, :, 0, :L]
        y = (lambda x, *d: x.permute(*d))(y, 0, 2, 1) + u * Dskip[None, None, :]
        return y

    def _B_ref(x, w1, w3, w2):
        gate = torch.einsum("bsd,df->bsf", x, w1)
        up = torch.einsum("bsd,df->bsf", x, w3)
        h = _silu(gate) * up
        out = torch.einsum("bsf,fd->bsd", h, w2)
        return out

    x = A_u
    xn = _layernorm(x, axis=-1)
    return x + _A_ref(xn, A_A_re, A_A_im, A_B_re, A_B_im, A_C_re, A_C_im, A_log_dt, A_Dskip) + _B_ref(xn, B_w1, B_w3, B_w2)
```

```asm
; @launch grid=(256,1,1) block=(512,1,1) lds=163840
.amdgcn_target "amdgcn-amd-amdhsa--gfx950"
.text
.globl parallel_sum__ssm_conv_s4__glu_gated_swiglu__prompt_kernel
.p2align 8
.type parallel_sum__ssm_conv_s4__glu_gated_swiglu__prompt_kernel,@function
parallel_sum__ssm_conv_s4__glu_gated_swiglu__prompt_kernel:
    s_cmp_ge_u32 s2, 256
    s_cbranch_scc1 L_end
    s_load_dwordx16 s[4:19], s[0:1], 0
    s_load_dwordx16 s[20:35], s[0:1], 64
    v_and_b32 v1, 63, v0
    v_lshrrev_b32 v2, 6, v0
    s_nop 0
    v_readfirstlane_b32 s40, v2
    s_nop 0
    s_cmp_eq_u32 s40, 7
    s_cbranch_scc0 L_pf_1
    s_cmp_ge_u32 s2, 240
    s_cbranch_scc0 L_pf_1
    s_getpc_b64 s[56:57]
L_pc_2:
    v_lshlrev_b32 v3, 7, v1
    global_load_dword v228, v3, s[56:57]
    s_add_u32 s56, s56, 8192
    s_addc_u32 s57, s57, 0
    global_load_dword v229, v3, s[56:57]
    s_add_u32 s56, s56, 8192
    s_addc_u32 s57, s57, 0
    global_load_dword v230, v3, s[56:57]
    s_add_u32 s56, s56, 8192
    s_addc_u32 s57, s57, 0
L_pf_1:
    s_and_b32 s56, s2, 7
    s_lshr_b32 s57, s2, 3
    s_and_b32 s58, s56, 1
    s_lshl_b32 s58, s58, 3
    s_and_b32 s59, s57, 7
    s_add_u32 s42, s58, s59
    s_lshr_b32 s58, s56, 1
    s_lshl_b32 s58, s58, 2
    s_lshr_b32 s59, s57, 3
    s_add_u32 s43, s58, s59
    s_and_b32 s58, s56, 3
    s_lshl_b32 s58, s58, 3
    s_and_b32 s59, s57, 7
    s_add_u32 s44, s58, s59
    s_lshr_b32 s58, s56, 2
    s_lshl_b32 s58, s58, 2
    s_lshr_b32 s59, s57, 3
    s_add_u32 s45, s58, s59
    s_mul_i32 s58, s56, 80
    s_add_u32 s46, s58, s57
    s_cmp_lt_u32 s57, 16
    s_cselect_b32 s47, 3, 2
    s_waitcnt lgkmcnt(0)
    s_mov_b32 s36, s34
    s_and_b32 s37, s35, 0xffff
    s_mov_b32 s38, 23068672
    s_mov_b32 s39, 0x20000
    v_lshlrev_b32 v211, 4, v1
    v_mov_b32 v215, 0
    s_cmp_ge_u32 s40, 4
    s_cbranch_scc1 L_kgen_3
    s_lshl_b32 s56, s2, 2
    s_add_u32 s56, s56, s40
    s_mul_i32 s56, s56, 2560
    s_mov_b32 s52, s4
    s_and_b32 s53, s5, 0xffff
    s_mov_b32 s54, 2621440
    s_mov_b32 s55, 0x20000
    v_lshlrev_b32 v2, 2, v1
    buffer_load_dword v10, v2, s[52:55], s56 offen offset:0
    buffer_load_dword v11, v2, s[52:55], s56 offen offset:256
    buffer_load_dword v12, v2, s[52:55], s56 offen offset:512
    buffer_load_dword v13, v2, s[52:55], s56 offen offset:768
    buffer_load_dword v14, v2, s[52:55], s56 offen offset:1024
    buffer_load_dword v15, v2, s[52:55], s56 offen offset:1280
    buffer_load_dword v16, v2, s[52:55], s56 offen offset:1536
    buffer_load_dword v17, v2, s[52:55], s56 offen offset:1792
    buffer_load_dword v18, v2, s[52:55], s56 offen offset:2048
    buffer_load_dword v19, v2, s[52:55], s56 offen offset:2304
    v_mov_b32 v2, 163712
    v_mov_b32 v3, 0
    v_lshl_add_u32 v2, v1, 2, v2
    s_mov_b64 s[58:59], exec
    s_mov_b32 exec_hi, 0
    ds_write_b32 v2, v3
    s_mov_b64 exec, s[58:59]
    s_waitcnt lgkmcnt(0)
    s_barrier
    s_lshl_b32 s65, s40, 12
    s_add_u32 s65, s65, 117248
    s_mov_b32 s66, 0
    s_cmp_ge_u32 s2, 240
    s_cbranch_scc1 L_nodma_5
    s_mov_b32 s66, 1
    v_lshrrev_b32 v3, 3, v1
    v_and_b32 v4, 7, v1
    v_lshlrev_b32 v4, 4, v4
    s_lshl_b32 s67, s2, 2
    s_add_u32 s67, s67, s40
    s_mul_hi_u32 s68, s67, 0x6666667
    s_mul_i32 s69, s68, 40
    s_sub_u32 s69, s67, s69
    v_mul_u32_u24 v5, 3072, v3
    v_add_u32 v5, v5, v4
    s_mul_i32 s56, s69, 49152
    s_lshl_b32 s57, s68, 7
    s_add_u32 s56, s56, s57
    s_mov_b32 s48, s24
    s_and_b32 s49, s25, 0xffff
    s_mov_b32 s50, 1966080
    s_mov_b32 s51, 0x20000
    s_add_u32 m0, s65, 0
    s_add_u32 s57, s56, 0
    buffer_load_dwordx4 v5, s[48:51], s57 offen lds
    s_add_u32 m0, s65, 1024
    s_add_u32 s57, s56, 24576
    buffer_load_dwordx4 v5, s[48:51], s57 offen lds
    s_mov_b32 s48, s26
    s_and_b32 s49, s27, 0xffff
    s_mov_b32 s50, 1966080
    s_mov_b32 s51, 0x20000
    s_add_u32 m0, s65, 2048
    s_add_u32 s57, s56, 0
    buffer_load_dwordx4 v5, s[48:51], s57 offen lds
    s_add_u32 m0, s65, 3072
    s_add_u32 s57, s56, 24576
    buffer_load_dwordx4 v5, s[48:51], s57 offen lds
    s_cmp_ge_u32 s40, 2
    s_cbranch_scc1 L_nodma_5
    s_mov_b32 s66, 3
    s_lshl_b32 s67, s2, 1
    s_add_u32 s67, s67, s40
    s_mul_hi_u32 s94, s67, 0x5555556
    s_mul_i32 s95, s94, 48
    s_sub_u32 s95, s67, s95
    v_mul_u32_u24 v215, 1280, v3
    v_add_u32 v215, v215, v4
    s_mul_i32 s96, s95, 40960
    s_lshl_b32 s57, s94, 7
    s_add_u32 s96, s96, s57
L_nodma_5:
    v_mov_b32 v2, 0
    s_mov_b32 s56, 20189184
    buffer_load_dword v107, v2, s[36:39], s56 offen sc1
    s_mov_b32 s57, 8
    s_mul_hi_u32 s60, s57, 0x55555556
    s_mul_i32 s61, s60, 3
    s_sub_u32 s61, s57, s61
    s_lshl_b32 s62, s60, 5
    s_add_u32 s62, s62, s46
    s_min_u32 s62, s62, 639
    s_mul_i32 s63, s62, 384
    s_lshl_b32 s61, s61, 7
    s_add_u32 s63, s63, s61
    v_lshlrev_b32 v2, 1, v1
    s_mov_b32 s48, s6
    s_and_b32 s49, s7, 0xffff
    s_mov_b32 s50, 245760
    s_mov_b32 s51, 0x20000
    buffer_load_ushort v100, v2, s[48:51], s63 offen
    s_mov_b32 s48, s8
    s_and_b32 s49, s9, 0xffff
    s_mov_b32 s50, 245760
    s_mov_b32 s51, 0x20000
    buffer_load_ushort v101, v2, s[48:51], s63 offen
    s_mov_b32 s48, s10
    s_and_b32 s49, s11, 0xffff
    s_mov_b32 s50, 245760
    s_mov_b32 s51, 0x20000
    buffer_load_ushort v102, v2, s[48:51], s63 offen
    s_mov_b32 s48, s12
    s_and_b32 s49, s13, 0xffff
    s_mov_b32 s50, 245760
    s_mov_b32 s51, 0x20000
    buffer_load_ushort v103, v2, s[48:51], s63 offen
    s_mov_b32 s48, s14
    s_and_b32 s49, s15, 0xffff
    s_mov_b32 s50, 245760
    s_mov_b32 s51, 0x20000
    buffer_load_ushort v104, v2, s[48:51], s63 offen
    s_mov_b32 s48, s16
    s_and_b32 s49, s17, 0xffff
    s_mov_b32 s50, 245760
    s_mov_b32 s51, 0x20000
    buffer_load_ushort v105, v2, s[48:51], s63 offen
    s_mov_b32 s48, s18
    s_and_b32 s49, s19, 0xffff
    s_mov_b32 s50, 1280
    s_mov_b32 s51, 0x20000
    s_lshl_b32 s62, s62, 1
    v_mov_b32 v3, 0
    buffer_load_ushort v106, v3, s[48:51], s62 offen
    v_and_b32 v2, 31, v1
    v_lshrrev_b32 v3, 5, v1
    v_lshlrev_b32 v3, 4, v3
    v_mul_u32_u24 v8, 272, v2
    v_add_u32 v109, v8, v3
    v_lshrrev_b32 v4, 2, v2
    v_mov_b32 v5, 0x3020100
    v_mov_b32 v6, 0x7060504
    v_cmp_eq_u32 vcc, 1, v4
    s_nop 1
    v_cndmask_b32 v5, v5, v6, vcc
    v_mov_b32 v6, 0xd0a0908
    v_cmp_eq_u32 vcc, 2, v4
    s_nop 1
    v_cndmask_b32 v5, v5, v6, vcc
    v_mov_b32 v6, 0x100c0b0a
    v_cmp_eq_u32 vcc, 3, v4
    s_nop 1
    v_cndmask_b32 v5, v5, v6, vcc
    v_mov_b32 v6, 0x14130f0e
    v_cmp_eq_u32 vcc, 4, v4
    s_nop 1
    v_cndmask_b32 v5, v5, v6, vcc
    v_mov_b32 v6, 0x18171211
    v_cmp_eq_u32 vcc, 5, v4
    s_nop 1
    v_cndmask_b32 v5, v5, v6, vcc
    v_mov_b32 v6, 0x1615
    v_cmp_eq_u32 vcc, 6, v4
    s_nop 1
    v_cndmask_b32 v5, v5, v6, vcc
    v_mov_b32 v6, 0x1a19
    v_cmp_eq_u32 vcc, 7, v4
    s_nop 1
    v_cndmask_b32 v5, v5, v6, vcc
    v_and_b32 v6, 3, v2
    v_lshlrev_b32 v6, 3, v6
    v_lshrrev_b32 v5, v6, v5
    v_and_b32 v5, 0xff, v5
    v_add_u32 v5, 32, v5
    v_mul_u32_u24 v9, 272, v5
    v_add_u32 v108, v9, v3
    v_and_b32 v3, 7, v1
    v_lshrrev_b32 v4, 3, v1
    v_mul_u32_u24 v208, 1296, v3
    v_lshl_add_u32 v208, v4, 4, v208
    v_add_u32 v208, 141824, v208
    v_lshrrev_b32 v209, 1, v4
    v_lshlrev_b32 v209, 10, v209
    v_and_b32 v7, 1, v4
    v_lshl_add_u32 v209, v7, 9, v209
    v_lshl_add_u32 v209, v3, 4, v209
    s_lshr_b32 s60, s2, 2
    s_mul_i32 s60, s60, 40960
    s_and_b32 s61, s2, 3
    s_lshl_b32 s61, s61, 7
    s_add_u32 s60, s60, s61
    s_add_u32 s60, s60, 0
    v_and_b32 v8, 15, v1
    v_lshrrev_b32 v9, 2, v8
    v_sub_u32 v5, 7, v9
    v_mul_u32_u24 v210, 1296, v5
    v_and_b32 v6, 3, v1
    v_lshl_add_u32 v210, v6, 3, v210
    v_lshrrev_b32 v4, 4, v1
    v_lshl_add_u32 v210, v4, 5, v210
    v_add_u32 v210, 141824, v210
    v_lshlrev_b32 v6, 3, v6
    v_and_b32 v7, 1, v4
    v_lshlrev_b32 v7, 11, v7
    v_lshrrev_b32 v8, 1, v4
    v_lshl_add_u32 v8, v8, 3, v9
    v_lshl_add_u32 v7, v8, 7, v7
    v_add3_u32 v212, v7, v6, s65
    v_lshrrev_b32 v7, 1, v4
    v_lshlrev_b32 v7, 4, v7
    v_and_b32 v8, 1, v4
    v_lshl_add_u32 v7, v8, 2, v7
    v_add_u32 v7, v7, v9
    v_lshlrev_b32 v7, 7, v7
    v_add3_u32 v213, v7, v6, s65
    s_lshl_b32 s56, s68, 2
    s_add_u32 s56, s56, 0
    s_mul_hi_u32 s57, s56, 0x2aaaaaab
    s_mul_i32 s58, s57, 6
    s_sub_u32 s58, s56, s58
    s_mul_i32 s57, s57, 40
    s_add_u32 s57, s57, s69
    s_mul_i32 s57, s57, 6
    s_add_u32 s57, s57, s58
    s_lshl_b32 s57, s57, 10
    s_add_u32 s6, s57, 5242880
    s_lshl_b32 s56, s68, 2
    s_add_u32 s56, s56, 1
    s_mul_hi_u32 s57, s56, 0x2aaaaaab
    s_mul_i32 s58, s57, 6
    s_sub_u32 s58, s56, s58
    s_mul_i32 s57, s57, 40
    s_add_u32 s57, s57, s69
    s_mul_i32 s57, s57, 6
    s_add_u32 s57, s57, s58
    s_lshl_b32 s57, s57, 10
    s_add_u32 s7, s57, 5242880
    s_lshl_b32 s56, s68, 2
    s_add_u32 s56, s56, 2
    s_mul_hi_u32 s57, s56, 0x2aaaaaab
    s_mul_i32 s58, s57, 6
    s_sub_u32 s58, s56, s58
    s_mul_i32 s57, s57, 40
    s_add_u32 s57, s57, s69
    s_mul_i32 s57, s57, 6
    s_add_u32 s57, s57, s58
    s_lshl_b32 s57, s57, 10
    s_add_u32 s8, s57, 5242880
    s_lshl_b32 s56, s68, 2
    s_add_u32 s56, s56, 3
    s_mul_hi_u32 s57, s56, 0x2aaaaaab
    s_mul_i32 s58, s57, 6
    s_sub_u32 s58, s56, s58
    s_mul_i32 s57, s57, 40
    s_add_u32 s57, s57, s69
    s_mul_i32 s57, s57, 6
    s_add_u32 s57, s57, s58
    s_lshl_b32 s57, s57, 10
    s_add_u32 s9, s57, 5242880
    s_mul_i32 s14, s40, 2592
    s_add_u32 s14, s14, 141824
    v_lshl_add_u32 v214, v1, 2, s14
    s_lshl_b32 s15, s40, 7
    v_add_u32 v208, s15, v208
    v_add_u32 v210, s15, v210
    s_lshl_b32 s15, s40, 12
    s_add_u32 s60, s60, s15
    s_mul_i32 s61, s2, 10240
    s_lshl_b32 s15, s40, 10
    s_add_u32 s61, s61, s15
    s_add_u32 s61, s61, 2621440
    s_lshl_b32 s16, s2, 7
    s_add_u32 s16, s16, 20054016
    s_mov_b32 s18, 0x3acccccd
    s_mov_b32 s19, s18
    s_cmp_eq_u32 s66, 3
    s_cbranch_scc1 L_w_6
    s_cmp_eq_u32 s66, 1
    s_cbranch_scc1 L_w_7
    s_waitcnt vmcnt(8)
    s_branch L_w_8
L_w_7:
L_w_6:
    s_waitcnt vmcnt(12)
L_w_8:
    v_lshlrev_b32 v20, 16, v10
    v_and_b32 v21, 0xffff0000, v10
    v_lshlrev_b32 v30, 16, v15
    v_and_b32 v31, 0xffff0000, v15
    v_lshlrev_b32 v22, 16, v11
    v_and_b32 v23, 0xffff0000, v11
    v_lshlrev_b32 v32, 16, v16
    v_and_b32 v33, 0xffff0000, v16
    v_lshlrev_b32 v24, 16, v12
    v_and_b32 v25, 0xffff0000, v12
    v_lshlrev_b32 v34, 16, v17
    v_and_b32 v35, 0xffff0000, v17
    v_lshlrev_b32 v26, 16, v13
    v_and_b32 v27, 0xffff0000, v13
    v_lshlrev_b32 v36, 16, v18
    v_and_b32 v37, 0xffff0000, v18
    v_lshlrev_b32 v28, 16, v14
    v_and_b32 v29, 0xffff0000, v14
    v_lshlrev_b32 v38, 16, v19
    v_and_b32 v39, 0xffff0000, v19
    v_pk_add_f32 v[4:5], v[20:21], v[22:23]
    v_pk_add_f32 v[40:41], v[30:31], v[32:33]
    v_pk_add_f32 v[4:5], v[4:5], v[24:25]
    v_pk_add_f32 v[40:41], v[40:41], v[34:35]
    v_pk_add_f32 v[4:5], v[4:5], v[26:27]
    v_pk_add_f32 v[40:41], v[40:41], v[36:37]
    v_pk_add_f32 v[4:5], v[4:5], v[28:29]
    v_pk_add_f32 v[40:41], v[40:41], v[38:39]
    v_add_f32 v4, v4, v5
    v_add_f32 v40, v40, v41
    s_nop 0
    v_add_f32_dpp v4, v4, v4 quad_perm:[1,0,3,2] row_mask:0xf bank_mask:0xf
    v_add_f32_dpp v40, v40, v40 quad_perm:[1,0,3,2] row_mask:0xf bank_mask:0xf
    s_nop 0
    v_add_f32_dpp v4, v4, v4 quad_perm:[2,3,0,1] row_mask:0xf bank_mask:0xf
    v_add_f32_dpp v40, v40, v40 quad_perm:[2,3,0,1] row_mask:0xf bank_mask:0xf
    s_nop 0
    v_add_f32_dpp v4, v4, v4 row_half_mirror row_mask:0xf bank_mask:0xf
    v_add_f32_dpp v40, v40, v40 row_half_mirror row_mask:0xf bank_mask:0xf
    s_nop 0
    v_add_f32_dpp v4, v4, v4 row_mirror row_mask:0xf bank_mask:0xf
    v_add_f32_dpp v40, v40, v40 row_mirror row_mask:0xf bank_mask:0xf
    s_nop 0
    v_add_f32_dpp v4, v4, v4 row_bcast:15 row_mask:0xa bank_mask:0xf
    v_add_f32_dpp v40, v40, v40 row_bcast:15 row_mask:0xa bank_mask:0xf
    s_nop 0
    v_add_f32_dpp v4, v4, v4 row_bcast:31 row_mask:0xc bank_mask:0xf
    v_add_f32_dpp v40, v40, v40 row_bcast:31 row_mask:0xc bank_mask:0xf
    v_readlane_b32 s56, v4, 63
    v_readlane_b32 s57, v40, 63
    s_nop 0
    v_mov_b32 v6, s56
    v_mov_b32 v42, s57
    v_mul_f32 v6, s18, v6
    v_mul_f32 v42, s18, v42
    v_pk_add_f32 v[20:21], v[20:21], v[6:7] op_sel_hi:[1,0] neg_lo:[0,1] neg_hi:[0,1]
    v_pk_add_f32 v[30:31], v[30:31], v[42:43] op_sel_hi:[1,0] neg_lo:[0,1] neg_hi:[0,1]
    v_pk_add_f32 v[22:23], v[22:23], v[6:7] op_sel_hi:[1,0] neg_lo:[0,1] neg_hi:[0,1]
    v_pk_add_f32 v[32:33], v[32:33], v[42:43] op_sel_hi:[1,0] neg_lo:[0,1] neg_hi:[0,1]
    v_pk_add_f32 v[24:25], v[24:25], v[6:7] op_sel_hi:[1,0] neg_lo:[0,1] neg_hi:[0,1]
    v_pk_add_f32 v[34:35], v[34:35], v[42:43] op_sel_hi:[1,0] neg_lo:[0,1] neg_hi:[0,1]
    v_pk_add_f32 v[26:27], v[26:27], v[6:7] op_sel_hi:[1,0] neg_lo:[0,1] neg_hi:[0,1]
    v_pk_add_f32 v[36:37], v[36:37], v[42:43] op_sel_hi:[1,0] neg_lo:[0,1] neg_hi:[0,1]
    v_pk_add_f32 v[28:29], v[28:29], v[6:7] op_sel_hi:[1,0] neg_lo:[0,1] neg_hi:[0,1]
    v_pk_add_f32 v[38:39], v[38:39], v[42:43] op_sel_hi:[1,0] neg_lo:[0,1] neg_hi:[0,1]
    v_pk_mul_f32 v[4:5], v[20:21], v[20:21]
    v_pk_mul_f32 v[40:41], v[30:31], v[30:31]
    v_pk_fma_f32 v[4:5], v[22:23], v[22:23], v[4:5]
    v_pk_fma_f32 v[40:41], v[32:33], v[32:33], v[40:41]
    v_pk_fma_f32 v[4:5], v[24:25], v[24:25], v[4:5]
    v_pk_fma_f32 v[40:41], v[34:35], v[34:35], v[40:41]
    v_pk_fma_f32 v[4:5], v[26:27], v[26:27], v[4:5]
    v_pk_fma_f32 v[40:41], v[36:37], v[36:37], v[40:41]
    v_pk_fma_f32 v[4:5], v[28:29], v[28:29], v[4:5]
    v_pk_fma_f32 v[40:41], v[38:39], v[38:39], v[40:41]
    v_add_f32 v4, v4, v5
    v_add_f32 v40, v40, v41
    s_nop 0
    v_add_f32_dpp v4, v4, v4 quad_perm:[1,0,3,2] row_mask:0xf bank_mask:0xf
    v_add_f32_dpp v40, v40, v40 quad_perm:[1,0,3,2] row_mask:0xf bank_mask:0xf
    s_nop 0
    v_add_f32_dpp v4, v4, v4 quad_perm:[2,3,0,1] row_mask:0xf bank_mask:0xf
    v_add_f32_dpp v40, v40, v40 quad_perm:[2,3,0,1] row_mask:0xf bank_mask:0xf
    s_nop 0
    v_add_f32_dpp v4, v4, v4 row_half_mirror row_mask:0xf bank_mask:0xf
    v_add_f32_dpp v40, v40, v40 row_half_mirror row_mask:0xf bank_mask:0xf
    s_nop 0
    v_add_f32_dpp v4, v4, v4 row_mirror row_mask:0xf bank_mask:0xf
    v_add_f32_dpp v40, v40, v40 row_mirror row_mask:0xf bank_mask:0xf
    s_nop 0
    v_add_f32_dpp v4, v4, v4 row_bcast:15 row_mask:0xa bank_mask:0xf
    v_add_f32_dpp v40, v40, v40 row_bcast:15 row_mask:0xa bank_mask:0xf
    s_nop 0
    v_add_f32_dpp v4, v4, v4 row_bcast:31 row_mask:0xc bank_mask:0xf
    v_add_f32_dpp v40, v40, v40 row_bcast:31 row_mask:0xc bank_mask:0xf
    v_readlane_b32 s56, v4, 63
    v_readlane_b32 s57, v40, 63
    s_nop 0
    v_mov_b32 v44, s56
    v_mov_b32 v46, s57
    v_mul_f32 v44, s18, v44
    v_mul_f32 v46, s18, v46
    v_cvt_pk_bf16_f32 v44, v44, v44
    v_lshlrev_b32 v44, 16, v44
    v_cvt_pk_bf16_f32 v46, v46, v46
    v_lshlrev_b32 v46, 16, v46
    v_add_f32 v44, 0x3727c5ac, v44
    v_add_f32 v46, 0x3727c5ac, v46
    v_cvt_pk_bf16_f32 v44, v44, v44
    v_lshlrev_b32 v44, 16, v44
    v_cvt_pk_bf16_f32 v46, v46, v46
    v_lshlrev_b32 v46, 16, v46
    v_sqrt_f32 v44, v44
    v_sqrt_f32 v46, v46
    v_cvt_pk_bf16_f32 v44, v44, v44
    v_lshlrev_b32 v44, 16, v44
    v_cvt_pk_bf16_f32 v46, v46, v46
    v_lshlrev_b32 v46, 16, v46
    v_rcp_f32 v44, v44
    v_rcp_f32 v46, v46
    v_pk_mul_f32 v[20:21], v[20:21], v[44:45] op_sel_hi:[1,0]
    v_pk_mul_f32 v[30:31], v[30:31], v[46:47] op_sel_hi:[1,0]
    v_cvt_pk_bf16_f32 v10, v20, v21
    v_cvt_pk_bf16_f32 v15, v30, v31
    v_pk_mul_f32 v[22:23], v[22:23], v[44:45] op_sel_hi:[1,0]
    v_pk_mul_f32 v[32:33], v[32:33], v[46:47] op_sel_hi:[1,0]
    v_cvt_pk_bf16_f32 v11, v22, v23
    v_cvt_pk_bf16_f32 v16, v32, v33
    v_pk_mul_f32 v[24:25], v[24:25], v[44:45] op_sel_hi:[1,0]
    v_pk_mul_f32 v[34:35], v[34:35], v[46:47] op_sel_hi:[1,0]
    v_cvt_pk_bf16_f32 v12, v24, v25
    v_cvt_pk_bf16_f32 v17, v34, v35
    v_pk_mul_f32 v[26:27], v[26:27], v[44:45] op_sel_hi:[1,0]
    v_pk_mul_f32 v[36:37], v[36:37], v[46:47] op_sel_hi:[1,0]
    v_cvt_pk_bf16_f32 v13, v26, v27
    v_cvt_pk_bf16_f32 v18, v36, v37
    v_pk_mul_f32 v[28:29], v[28:29], v[44:45] op_sel_hi:[1,0]
    v_pk_mul_f32 v[38:39], v[38:39], v[46:47] op_sel_hi:[1,0]
    v_cvt_pk_bf16_f32 v14, v28, v29
    v_cvt_pk_bf16_f32 v19, v38, v39
    ds_write_b32 v214, v10 offset:0
    ds_write_b32 v214, v15 offset:1296
    ds_write_b32 v214, v11 offset:256
    ds_write_b32 v214, v16 offset:1552
    ds_write_b32 v214, v12 offset:512
    ds_write_b32 v214, v17 offset:1808
    ds_write_b32 v214, v13 offset:768
    ds_write_b32 v214, v18 offset:2064
    ds_write_b32 v214, v14 offset:1024
    ds_write_b32 v214, v19 offset:2320
    v_mov_b32 v4, 163744
    v_mov_b32 v5, 1
    s_waitcnt lgkmcnt(0)
    s_mov_b64 exec, 1
    ds_add_u32 v4, v5
    s_mov_b64 exec, -1
    v_mov_b32 v4, 163744
    s_mov_b32 s57, 0
L_lw_9:
    ds_read_b32 v5, v4
    s_waitcnt lgkmcnt(0)
    v_readfirstlane_b32 s56, v5
    s_nop 0
    s_cmp_eq_u32 s56, 4
    s_cbranch_scc1 L_lwd_10
    s_add_u32 s57, s57, 1
    s_cmp_gt_u32 s57, 262144
    s_cbranch_scc1 L_lwd_10
    s_sleep 1
    s_branch L_lw_9
L_lwd_10:
    ds_read_b128 v[20:23], v208
    ds_read_b128 v[24:27], v208 offset:512
    s_cmp_lt_u32 s40, 2
    s_cbranch_scc0 L_q_11
    ds_read_b128 v[28:31], v208 offset:1024
    s_add_u32 s57, s60, 32768
    s_waitcnt lgkmcnt(0)
    buffer_store_dwordx4 v[28:31], v209, s[36:39], s57 offen sc1
L_q_11:
    s_add_u32 s57, s60, 16384
    s_waitcnt lgkmcnt(0)
    buffer_store_dwordx4 v[20:23], v209, s[36:39], s60 offen sc1
    buffer_store_dwordx4 v[24:27], v209, s[36:39], s57 offen sc1
    s_cmp_lt_u32 s40, 2
    s_cbranch_scc1 L_q_12
    s_waitcnt vmcnt(2)
L_q_12:
    s_waitcnt vmcnt(3)
    s_cmp_eq_u32 s66, 0
    s_cbranch_scc1 L_rldone_13
    ds_read_b64_tr_b16 v[28:29], v212 offset:0
    ds_read_b64_tr_b16 v[30:31], v212 offset:512
    ds_read_b64_tr_b16 v[32:33], v212 offset:32
    ds_read_b64_tr_b16 v[34:35], v212 offset:544
    ds_read_b64_tr_b16 v[36:37], v212 offset:64
    ds_read_b64_tr_b16 v[38:39], v212 offset:576
    ds_read_b64_tr_b16 v[40:41], v212 offset:96
    ds_read_b64_tr_b16 v[42:43], v212 offset:608
    s_waitcnt lgkmcnt(6)
    buffer_store_dwordx4 v[28:31], v211, s[36:39], s6 offen sc1
    s_waitcnt lgkmcnt(4)
    buffer_store_dwordx4 v[32:35], v211, s[36:39], s7 offen sc1
    s_waitcnt lgkmcnt(2)
    buffer_store_dwordx4 v[36:39], v211, s[36:39], s8 offen sc1
    s_waitcnt lgkmcnt(0)
    buffer_store_dwordx4 v[40:43], v211, s[36:39], s9 offen sc1
L_rldone_13:
    s_cmp_eq_u32 s66, 3
    s_cbranch_scc0 L_nw2_14
    s_mov_b32 s48, s28
    s_and_b32 s49, s29, 0xffff
    s_mov_b32 s50, 1966080
    s_mov_b32 s51, 0x20000
    s_add_u32 m0, s65, 16384
    s_add_u32 s57, s96, 0
    buffer_load_dwordx4 v215, s[48:51], s57 offen lds
    s_add_u32 m0, s65, 17408
    s_add_u32 s57, s96, 10240
    buffer_load_dwordx4 v215, s[48:51], s57 offen lds
    s_add_u32 m0, s65, 18432
    s_add_u32 s57, s96, 20480
    buffer_load_dwordx4 v215, s[48:51], s57 offen lds
    s_add_u32 m0, s65, 19456
    s_add_u32 s57, s96, 30720
    buffer_load_dwordx4 v215, s[48:51], s57 offen lds
L_nw2_14:
    v_readfirstlane_b32 s41, v107
    s_nop 0
    s_mul_i32 s41, s41, 0x19660d
    s_add_u32 s41, s41, 0x3c6ef35f
    s_lshl_b32 s56, s94, 2
    s_add_u32 s56, s56, 0
    s_mul_hi_u32 s57, s56, 0x33333334
    s_mul_i32 s58, s57, 5
    s_sub_u32 s58, s56, s58
    s_mul_i32 s57, s57, 48
    s_add_u32 s57, s57, s95
    s_mul_i32 s57, s57, 5
    s_add_u32 s57, s57, s58
    s_lshl_b32 s57, s57, 10
    s_add_u32 s10, s57, 9175040
    s_lshl_b32 s56, s94, 2
    s_add_u32 s56, s56, 1
    s_mul_hi_u32 s57, s56, 0x33333334
    s_mul_i32 s58, s57, 5
    s_sub_u32 s58, s56, s58
    s_mul_i32 s57, s57, 48
    s_add_u32 s57, s57, s95
    s_mul_i32 s57, s57, 5
    s_add_u32 s57, s57, s58
    s_lshl_b32 s57, s57, 10
    s_add_u32 s11, s57, 9175040
    s_lshl_b32 s56, s94, 2
    s_add_u32 s56, s56, 2
    s_mul_hi_u32 s57, s56, 0x33333334
    s_mul_i32 s58, s57, 5
    s_sub_u32 s58, s56, s58
    s_mul_i32 s57, s57, 48
    s_add_u32 s57, s57, s95
    s_mul_i32 s57, s57, 5
    s_add_u32 s57, s57, s58
    s_lshl_b32 s57, s57, 10
    s_add_u32 s12, s57, 9175040
    s_lshl_b32 s56, s94, 2
    s_add_u32 s56, s56, 3
    s_mul_hi_u32 s57, s56, 0x33333334
    s_mul_i32 s58, s57, 5
    s_sub_u32 s58, s56, s58
    s_mul_i32 s57, s57, 48
    s_add_u32 s57, s57, s95
    s_mul_i32 s57, s57, 5
    s_add_u32 s57, s57, s58
    s_lshl_b32 s57, s57, 10
    s_add_u32 s13, s57, 9175040
    v_mov_b32 v80, 0
    v_mov_b32 v81, 0
    v_mov_b32 v82, 0
    v_mov_b32 v83, 0
    v_mov_b32 v84, 0
    v_mov_b32 v85, 0
    v_mov_b32 v86, 0
    v_mov_b32 v87, 0
    v_mov_b32 v88, 0
    v_mov_b32 v89, 0
    v_mov_b32 v90, 0
    v_mov_b32 v91, 0
    v_mov_b32 v92, 0
    v_mov_b32 v93, 0
    v_mov_b32 v94, 0
    v_mov_b32 v95, 0
    v_mov_b32 v96, 0
    v_mov_b32 v97, 0
    v_mov_b32 v98, 0
    v_mov_b32 v99, 0
    v_mov_b32 v110, 0
    v_mov_b32 v111, 0
    v_mov_b32 v112, 0
    v_mov_b32 v113, 0
    v_mov_b32 v114, 0
    v_mov_b32 v115, 0
    v_mov_b32 v116, 0
    v_mov_b32 v117, 0
    v_mov_b32 v118, 0
    v_mov_b32 v119, 0
    v_mov_b32 v120, 0
    v_mov_b32 v121, 0
    v_mov_b32 v122, 0
    v_mov_b32 v123, 0
    v_mov_b32 v124, 0
    v_mov_b32 v125, 0
    v_mov_b32 v126, 0
    v_mov_b32 v127, 0
    v_mov_b32 v128, 0
    v_mov_b32 v129, 0
    v_mov_b32 v130, 0
    v_mov_b32 v131, 0
    v_mov_b32 v132, 0
    v_mov_b32 v133, 0
    v_mov_b32 v134, 0
    v_mov_b32 v135, 0
    v_mov_b32 v136, 0
    v_mov_b32 v137, 0
    v_mov_b32 v138, 0
    v_mov_b32 v139, 0
    v_mov_b32 v140, 0
    v_mov_b32 v141, 0
    v_mov_b32 v142, 0
    v_mov_b32 v143, 0
    v_mov_b32 v144, 0
    v_mov_b32 v145, 0
    v_mov_b32 v146, 0
    v_mov_b32 v147, 0
    v_mov_b32 v148, 0
    v_mov_b32 v149, 0
    v_mov_b32 v150, 0
    v_mov_b32 v151, 0
    v_mov_b32 v152, 0
    v_mov_b32 v153, 0
    v_mov_b32 v154, 0
    v_mov_b32 v155, 0
    v_mov_b32 v156, 0
    v_mov_b32 v157, 0
    v_mov_b32 v158, 0
    v_mov_b32 v159, 0
    s_cmp_eq_u32 s66, 3
    s_cbranch_scc1 L_v_16
    s_waitcnt vmcnt(0)
L_v_16:
    s_waitcnt vmcnt(4)
    v_mov_b32 v2, 163712
    v_mov_b32 v3, 1
    s_mov_b64 s[58:59], exec
    s_mov_b64 exec, 1
    ds_add_rtn_u32 v3, v2, v3
    s_waitcnt lgkmcnt(0)
    v_readfirstlane_b32 s56, v3
    s_nop 0
    s_add_u32 s56, s56, 1
    s_cmp_lg_u32 s56, 4
    s_cbranch_scc1 L_sig_17
    v_mov_b32 v2, 0
    v_mov_b32 v3, s41
    buffer_store_dword v3, v2, s[36:39], s16 offen sc1
L_sig_17:
    s_mov_b64 exec, s[58:59]
    s_cmp_eq_u32 s40, 3
    s_cbranch_scc0 L_retA_19
    s_cmp_eq_u32 s47, 3
    s_cbranch_scc0 L_retA_19
    s_mov_b32 s66, 8
    s_mov_b32 s67, 9
    s_mov_b32 s63, 64192
    s_branch L_unit_18
L_retA_19:
    ds_read_b64_tr_b16 v[4:5], v210
    ds_read_b64_tr_b16 v[8:9], v210 offset:512
    v_subrev_u32 v2, 5184, v210
    ds_read_b64_tr_b16 v[6:7], v2
    ds_read_b64_tr_b16 v[10:11], v2 offset:512
    s_cmp_lt_u32 s40, 2
    s_cbranch_scc0 L_xnt_20
    ds_read_b64_tr_b16 v[12:13], v210 offset:1024
    ds_read_b64_tr_b16 v[14:15], v2 offset:1024
    s_add_u32 s58, s61, 8192
    s_waitcnt lgkmcnt(0)
    buffer_store_dwordx4 v[12:15], v211, s[36:39], s58 offen sc1
L_xnt_20:
    s_add_u32 s58, s61, 4096
    s_waitcnt lgkmcnt(0)
    buffer_store_dwordx4 v[4:7], v211, s[36:39], s61 offen sc1
    buffer_store_dwordx4 v[8:11], v211, s[36:39], s58 offen sc1
    s_cmp_lt_u32 s40, 2
    s_cbranch_scc0 L_now2_21
    s_cmp_lt_u32 s2, 240
    s_cbranch_scc0 L_now2_21
    s_waitcnt vmcnt(3)
    ds_read_b64_tr_b16 v[176:177], v213 offset:16384
    ds_read_b64_tr_b16 v[178:179], v213 offset:17408
    ds_read_b64_tr_b16 v[180:181], v213 offset:16416
    ds_read_b64_tr_b16 v[182:183], v213 offset:17440
    ds_read_b64_tr_b16 v[184:185], v213 offset:16448
    ds_read_b64_tr_b16 v[186:187], v213 offset:17472
    ds_read_b64_tr_b16 v[188:189], v213 offset:16480
    ds_read_b64_tr_b16 v[190:191], v213 offset:17504
    s_waitcnt lgkmcnt(6)
    buffer_store_dwordx4 v[176:179], v211, s[36:39], s10 offen sc1
    s_waitcnt lgkmcnt(4)
    buffer_store_dwordx4 v[180:183], v211, s[36:39], s11 offen sc1
    s_waitcnt lgkmcnt(2)
    buffer_store_dwordx4 v[184:187], v211, s[36:39], s12 offen sc1
    s_waitcnt lgkmcnt(0)
    buffer_store_dwordx4 v[188:191], v211, s[36:39], s13 offen sc1
L_now2_21:
    s_waitcnt lgkmcnt(0)
    s_barrier
    s_cmp_ge_u32 s40, s47
    s_cbranch_scc1 L_nosum_22
    s_mul_i32 s63, s40, 12288
    s_add_u32 s63, s63, 80240
    v_lshl_add_u32 v3, v1, 4, s63
    ds_read_b128 v[16:19], v3 offset:0
    ds_read_b128 v[20:23], v3 offset:1024
    ds_read_b128 v[24:27], v3 offset:2048
    ds_read_b128 v[28:31], v3 offset:3072
    ds_read_b128 v[32:35], v3 offset:4096
    ds_read_b128 v[36:39], v3 offset:5120
    ds_read_b128 v[40:43], v3 offset:6144
    ds_read_b128 v[44:47], v3 offset:7168
    ds_read_b128 v[48:51], v3 offset:8192
    ds_read_b128 v[52:55], v3 offset:9216
    ds_read_b128 v[56:59], v3 offset:10240
    ds_read_b128 v[60:63], v3 offset:11264
    s_waitcnt lgkmcnt(0)
L_nosum_22:
    s_barrier
    s_branch L_teamA_23
L_kgen_3:
    s_sub_u32 s66, s40, 4
    s_mul_hi_u32 s60, s66, 0x55555556
    s_mul_i32 s61, s60, 3
    s_sub_u32 s61, s66, s61
    s_lshl_b32 s62, s60, 5
    s_add_u32 s62, s62, s46
    s_min_u32 s62, s62, 639
    s_mul_i32 s63, s62, 384
    s_lshl_b32 s61, s61, 7
    s_add_u32 s63, s63, s61
    v_lshlrev_b32 v2, 1, v1
    s_mov_b32 s48, s6
    s_and_b32 s49, s7, 0xffff
    s_mov_b32 s50, 245760
    s_mov_b32 s51, 0x20000
    buffer_load_ushort v100, v2, s[48:51], s63 offen
    s_mov_b32 s48, s8
    s_and_b32 s49, s9, 0xffff
    s_mov_b32 s50, 245760
    s_mov_b32 s51, 0x20000
    buffer_load_ushort v101, v2, s[48:51], s63 offen
    s_mov_b32 s48, s10
    s_and_b32 s49, s11, 0xffff
    s_mov_b32 s50, 245760
    s_mov_b32 s51, 0x20000
    buffer_load_ushort v102, v2, s[48:51], s63 offen
    s_mov_b32 s48, s12
    s_and_b32 s49, s13, 0xffff
    s_mov_b32 s50, 245760
    s_mov_b32 s51, 0x20000
    buffer_load_ushort v103, v2, s[48:51], s63 offen
    s_mov_b32 s48, s14
    s_and_b32 s49, s15, 0xffff
    s_mov_b32 s50, 245760
    s_mov_b32 s51, 0x20000
    buffer_load_ushort v104, v2, s[48:51], s63 offen
    s_mov_b32 s48, s16
    s_and_b32 s49, s17, 0xffff
    s_mov_b32 s50, 245760
    s_mov_b32 s51, 0x20000
    buffer_load_ushort v105, v2, s[48:51], s63 offen
    s_mov_b32 s48, s18
    s_and_b32 s49, s19, 0xffff
    s_mov_b32 s50, 1280
    s_mov_b32 s51, 0x20000
    s_lshl_b32 s62, s62, 1
    v_mov_b32 v3, 0
    buffer_load_ushort v106, v3, s[48:51], s62 offen
    s_barrier
    s_add_u32 s57, s66, 4
    s_mul_hi_u32 s60, s57, 0x55555556
    s_mul_i32 s61, s60, 3
    s_sub_u32 s61, s57, s61
    s_lshl_b32 s62, s60, 5
    s_add_u32 s62, s62, s46
    s_min_u32 s62, s62, 639
    s_mul_i32 s63, s62, 384
    s_lshl_b32 s61, s61, 7
    s_add_u32 s63, s63, s61
    v_lshlrev_b32 v2, 1, v1
    s_mov_b32 s48, s6
    s_and_b32 s49, s7, 0xffff
    s_mov_b32 s50, 245760
    s_mov_b32 s51, 0x20000
    buffer_load_ushort v192, v2, s[48:51], s63 offen
    s_mov_b32 s48, s8
    s_and_b32 s49, s9, 0xffff
    s_mov_b32 s50, 245760
    s_mov_b32 s51, 0x20000
    buffer_load_ushort v193, v2, s[48:51], s63 offen
    s_mov_b32 s48, s10
    s_and_b32 s49, s11, 0xffff
    s_mov_b32 s50, 245760
    s_mov_b32 s51, 0x20000
    buffer_load_ushort v194, v2, s[48:51], s63 offen
    s_mov_b32 s48, s12
    s_and_b32 s49, s13, 0xffff
    s_mov_b32 s50, 245760
    s_mov_b32 s51, 0x20000
    buffer_load_ushort v195, v2, s[48:51], s63 offen
    s_mov_b32 s48, s14
    s_and_b32 s49, s15, 0xffff
    s_mov_b32 s50, 245760
    s_mov_b32 s51, 0x20000
    buffer_load_ushort v196, v2, s[48:51], s63 offen
    s_mov_b32 s48, s16
    s_and_b32 s49, s17, 0xffff
    s_mov_b32 s50, 245760
    s_mov_b32 s51, 0x20000
    buffer_load_ushort v197, v2, s[48:51], s63 offen
    s_mov_b32 s48, s18
    s_and_b32 s49, s19, 0xffff
    s_mov_b32 s50, 1280
    s_mov_b32 s51, 0x20000
    s_lshl_b32 s62, s62, 1
    v_mov_b32 v3, 0
    buffer_load_ushort v198, v3, s[48:51], s62 offen
    s_mov_b32 s48, s20
    s_and_b32 s49, s21, 0xffff
    s_mov_b32 s50, 1280
    s_mov_b32 s51, 0x20000
    s_lshl_b32 s62, s66, 5
    s_add_u32 s62, s62, s46
    s_min_u32 s62, s62, 639
    s_lshl_b32 s62, s62, 1
    v_mov_b32 v2, 0
    buffer_load_ushort v216, v2, s[48:51], s62 offen
    v_mov_b32 v2, 0
    s_mov_b32 s56, 20189184
    buffer_load_dword v107, v2, s[36:39], s56 offen sc1
    v_and_b32 v2, 31, v1
    v_lshrrev_b32 v3, 5, v1
    v_lshlrev_b32 v3, 4, v3
    v_mul_u32_u24 v8, 272, v2
    v_add_u32 v109, v8, v3
    v_lshrrev_b32 v4, 2, v2
    v_mov_b32 v5, 0x3020100
    v_mov_b32 v6, 0x7060504
    v_cmp_eq_u32 vcc, 1, v4
    s_nop 1
    v_cndmask_b32 v5, v5, v6, vcc
    v_mov_b32 v6, 0xd0a0908
    v_cmp_eq_u32 vcc, 2, v4
    s_nop 1
    v_cndmask_b32 v5, v5, v6, vcc
    v_mov_b32 v6, 0x100c0b0a
    v_cmp_eq_u32 vcc, 3, v4
    s_nop 1
    v_cndmask_b32 v5, v5, v6, vcc
    v_mov_b32 v6, 0x14130f0e
    v_cmp_eq_u32 vcc, 4, v4
    s_nop 1
    v_cndmask_b32 v5, v5, v6, vcc
    v_mov_b32 v6, 0x18171211
    v_cmp_eq_u32 vcc, 5, v4
    s_nop 1
    v_cndmask_b32 v5, v5, v6, vcc
    v_mov_b32 v6, 0x1615
    v_cmp_eq_u32 vcc, 6, v4
    s_nop 1
    v_cndmask_b32 v5, v5, v6, vcc
    v_mov_b32 v6, 0x1a19
    v_cmp_eq_u32 vcc, 7, v4
    s_nop 1
    v_cndmask_b32 v5, v5, v6, vcc
    v_and_b32 v6, 3, v2
    v_lshlrev_b32 v6, 3, v6
    v_lshrrev_b32 v5, v6, v5
    v_and_b32 v5, 0xff, v5
    v_add_u32 v5, 32, v5
    v_mul_u32_u24 v9, 272, v5
    v_add_u32 v108, v9, v3
    s_mul_i32 s67, s47, 3
    s_min_u32 s67, s67, 8
    s_sub_u32 s63, s40, 4
    s_mul_i32 s63, s63, 16048
    s_waitcnt vmcnt(9)
L_unit_18:
    v_lshlrev_b32 v100, 16, v100
    v_lshlrev_b32 v101, 16, v101
    v_lshlrev_b32 v102, 16, v102
    v_lshlrev_b32 v103, 16, v103
    v_lshlrev_b32 v104, 16, v104
    v_lshlrev_b32 v105, 16, v105
    v_lshlrev_b32 v106, 16, v106
    v_mul_f32 v17, 0x3fb8aa3b, v106
    s_mov_b32 s64, 0x3fb8aa3b
    v_fma_f32 v18, v106, s64, -v17
    s_mov_b32 s64, 0x32a57060
    v_fma_f32 v18, v106, s64, v18
    v_exp_f32 v17, v17
    v_mul_f32 v18, 0x3f317218, v18
    v_fma_f32 v17, v17, v18, v17
    v_cvt_pk_bf16_f32 v17, v17, v17
    v_lshlrev_b32 v17, 16, v17
    v_mul_f32 v10, v100, v17
    v_mul_f32 v11, v101, v17
    v_mul_f32 v12, v102, v17
    v_mul_f32 v13, v103, v17
    v_mov_b32 v14, v104
    v_mov_b32 v15, v105
    v_pk_mul_f32 v[30:31], v[14:15], v[12:13] op_sel:[0,0] op_sel_hi:[0,1]
    v_pk_fma_f32 v[30:31], v[14:15], v[12:13], v[30:31] op_sel:[1,1,0] op_sel_hi:[1,0,1] neg_lo:[0,1,0]
    v_mul_f32 v10, 0x3fb8aa3b, v10
    v_mul_f32 v11, 0x3e22f983, v11
    v_mul_f32 v24, 0x41000000, v10
    v_mul_f32 v25, 0x41000000, v11
    v_exp_f32 v24, v24
    v_fract_f32 v25, v25
    v_cos_f32 v26, v25
    v_sin_f32 v27, v25
    v_mul_f32 v20, v24, v26
    v_mul_f32 v21, v24, v27
    v_mul_f32 v24, 0x3f800000, v10
    v_mul_f32 v25, 0x3f800000, v11
    v_exp_f32 v24, v24
    v_fract_f32 v25, v25
    v_cos_f32 v26, v25
    v_sin_f32 v27, v25
    v_mul_f32 v18, v24, v26
    v_mul_f32 v19, v24, v27
    v_mul_f32 v24, 0x43800000, v10
    v_mul_f32 v25, 0x43800000, v11
    v_exp_f32 v24, v24
    v_fract_f32 v25, v25
    v_cos_f32 v26, v25
    v_sin_f32 v27, v25
    v_mul_f32 v22, v24, v26
    v_mul_f32 v23, v24, v27
    s_mov_b32 m0, s63
    v_mov_b32 v4, 0x00003f80
    ds_write_addtid_b32 v4 offset:0
    v_cvt_pk_bf16_f32 v5, v20, v21
    ds_write_addtid_b32 v5 offset:272
    v_pk_mul_f32 v[24:25], v[20:21], v[20:21] op_sel:[0,0] op_sel_hi:[0,1]
    v_pk_fma_f32 v[24:25], v[20:21], v[20:21], v[24:25] op_sel:[1,1,0] op_sel_hi:[1,0,1] neg_lo:[0,1,0]
    v_cvt_pk_bf16_f32 v6, v24, v25
    ds_write_addtid_b32 v6 offset:544
    v_pk_mul_f32 v[26:27], v[24:25], v[20:21] op_sel:[0,0] op_sel_hi:[0,1]
    v_pk_fma_f32 v[26:27], v[24:25], v[20:21], v[26:27] op_sel:[1,1,0] op_sel_hi:[1,0,1] neg_lo:[0,1,0]
    v_cvt_pk_bf16_f32 v7, v26, v27
    ds_write_addtid_b32 v7 offset:816
    v_cvt_pk_bf16_f32 v4, v30, -v31
    ds_write_addtid_b32 v4 offset:8704
    v_pk_mul_f32 v[24:25], v[26:27], v[20:21] op_sel:[0,0] op_sel_hi:[0,1]
    v_pk_fma_f32 v[24:25], v[26:27], v[20:21], v[24:25] op_sel:[1,1,0] op_sel_hi:[1,0,1] neg_lo:[0,1,0]
    v_cvt_pk_bf16_f32 v5, v24, v25
    ds_write_addtid_b32 v5 offset:1088
    v_pk_mul_f32 v[32:33], v[30:31], v[18:19] op_sel:[0,0] op_sel_hi:[0,1]
    v_pk_fma_f32 v[32:33], v[30:31], v[18:19], v[32:33] op_sel:[1,1,0] op_sel_hi:[1,0,1] neg_lo:[0,1,0]
    v_cvt_pk_bf16_f32 v6, v32, -v33
    ds_write_addtid_b32 v6 offset:8976
    v_pk_mul_f32 v[26:27], v[24:25], v[20:21] op_sel:[0,0] op_sel_hi:[0,1]
    v_pk_fma_f32 v[26:27], v[24:25], v[20:21], v[26:27] op_sel:[1,1,0] op_sel_hi:[1,0,1] neg_lo:[0,1,0]
    v_cvt_pk_bf16_f32 v7, v26, v27
    ds_write_addtid_b32 v7 offset:1360
    v_pk_mul_f32 v[34:35], v[32:33], v[18:19] op_sel:[0,0] op_sel_hi:[0,1]
    v_pk_fma_f32 v[34:35], v[32:33], v[18:19], v[34:35] op_sel:[1,1,0] op_sel_hi:[1,0,1] neg_lo:[0,1,0]
    v_cvt_pk_bf16_f32 v4, v34, -v35
    ds_write_addtid_b32 v4 offset:9248
    v_pk_mul_f32 v[24:25], v[26:27], v[20:21] op_sel:[0,0] op_sel_hi:[0,1]
    v_pk_fma_f32 v[24:25], v[26:27], v[20:21], v[24:25] op_sel:[1,1,0] op_sel_hi:[1,0,1] neg_lo:[0,1,0]
    v_cvt_pk_bf16_f32 v5, v24, v25
    ds_write_addtid_b32 v5 offset:1632
    v_pk_mul_f32 v[36:37], v[34:35], v[18:19] op_sel:[0,0] op_sel_hi:[0,1]
    v_pk_fma_f32 v[36:37], v[34:35], v[18:19], v[36:37] op_sel:[1,1,0] op_sel_hi:[1,0,1] neg_lo:[0,1,0]
    v_cvt_pk_bf16_f32 v6, v36, -v37
    ds_write_addtid_b32 v6 offset:9520
    v_pk_mul_f32 v[26:27], v[24:25], v[20:21] op_sel:[0,0] op_sel_hi:[0,1]
    v_pk_fma_f32 v[26:27], v[24:25], v[20:21], v[26:27] op_sel:[1,1,0] op_sel_hi:[1,0,1] neg_lo:[0,1,0]
    v_cvt_pk_bf16_f32 v7, v26, v27
    ds_write_addtid_b32 v7 offset:1904
    v_pk_mul_f32 v[38:39], v[36:37], v[18:19] op_sel:[0,0] op_sel_hi:[0,1]
    v_pk_fma_f32 v[38:39], v[36:37], v[18:19], v[38:39] op_sel:[1,1,0] op_sel_hi:[1,0,1] neg_lo:[0,1,0]
    v_cvt_pk_bf16_f32 v4, v38, -v39
    ds_write_addtid_b32 v4 offset:9792
    v_pk_mul_f32 v[24:25], v[26:27], v[20:21] op_sel:[0,0] op_sel_hi:[0,1]
    v_pk_fma_f32 v[24:25], v[26:27], v[20:21], v[24:25] op_sel:[1,1,0] op_sel_hi:[1,0,1] neg_lo:[0,1,0]
    v_cvt_pk_bf16_f32 v5, v24, v25
    ds_write_addtid_b32 v5 offset:2176
    v_pk_mul_f32 v[40:41], v[38:39], v[18:19] op_sel:[0,0] op_sel_hi:[0,1]
    v_pk_fma_f32 v[40:41], v[38:39], v[18:19], v[40:41] op_sel:[1,1,0] op_sel_hi:[1,0,1] neg_lo:[0,1,0]
    v_cvt_pk_bf16_f32 v6, v40, -v41
    ds_write_addtid_b32 v6 offset:10064
    v_pk_mul_f32 v[26:27], v[24:25], v[20:21] op_sel:[0,0] op_sel_hi:[0,1]
    v_pk_fma_f32 v[26:27], v[24:25], v[20:21], v[26:27] op_sel:[1,1,0] op_sel_hi:[1,0,1] neg_lo:[0,1,0]
    v_cvt_pk_bf16_f32 v7, v26, v27
    ds_write_addtid_b32 v7 offset:2448
    v_pk_mul_f32 v[42:43], v[40:41], v[18:19] op_sel:[0,0] op_sel_hi:[0,1]
    v_pk_fma_f32 v[42:43], v[40:41], v[18:19], v[42:43] op_sel:[1,1,0] op_sel_hi:[1,0,1] neg_lo:[0,1,0]
    v_cvt_pk_bf16_f32 v4, v42, -v43
    ds_write_addtid_b32 v4 offset:10336
    v_pk_mul_f32 v[24:25], v[26:27], v[20:21] op_sel:[0,0] op_sel_hi:[0,1]
    v_pk_fma_f32 v[24:25], v[26:27], v[20:21], v[24:25] op_sel:[1,1,0] op_sel_hi:[1,0,1] neg_lo:[0,1,0]
    v_cvt_pk_bf16_f32 v5, v24, v25
    ds_write_addtid_b32 v5 offset:2720
    v_pk_mul_f32 v[44:45], v[42:43], v[18:19] op_sel:[0,0] op_sel_hi:[0,1]
    v_pk_fma_f32 v[44:45], v[42:43], v[18:19], v[44:45] op_sel:[1,1,0] op_sel_hi:[1,0,1] neg_lo:[0,1,0]
    v_cvt_pk_bf16_f32 v6, v44, -v45
    ds_write_addtid_b32 v6 offset:10608
    v_pk_mul_f32 v[26:27], v[24:25], v[20:21] op_sel:[0,0] op_sel_hi:[0,1]
    v_pk_fma_f32 v[26:27], v[24:25], v[20:21], v[26:27] op_sel:[1,1,0] op_sel_hi:[1,0,1] neg_lo:[0,1,0]
    v_cvt_pk_bf16_f32 v7, v26, v27
    ds_write_addtid_b32 v7 offset:2992
    v_pk_mul_f32 v[46:47], v[44:45], v[18:19] op_sel:[0,0] op_sel_hi:[0,1]
    v_pk_fma_f32 v[46:47], v[44:45], v[18:19], v[46:47] op_sel:[1,1,0] op_sel_hi:[1,0,1] neg_lo:[0,1,0]
    v_pk_mul_f32 v[24:25], v[26:27], v[20:21] op_sel:[0,0] op_sel_hi:[0,1]
    v_pk_fma_f32 v[24:25], v[26:27], v[20:21], v[24:25] op_sel:[1,1,0] op_sel_hi:[1,0,1] neg_lo:[0,1,0]
    v_cvt_pk_bf16_f32 v4, v24, v25
    ds_write_addtid_b32 v4 offset:3264
    v_pk_mul_f32 v[50:51], v[22:23], v[22:23] op_sel:[0,0] op_sel_hi:[0,1]
    v_pk_fma_f32 v[50:51], v[22:23], v[22:23], v[50:51] op_sel:[1,1,0] op_sel_hi:[1,0,1] neg_lo:[0,1,0]
    v_pk_mul_f32 v[26:27], v[24:25], v[20:21] op_sel:[0,0] op_sel_hi:[0,1]
    v_pk_fma_f32 v[26:27], v[24:25], v[20:21], v[26:27] op_sel:[1,1,0] op_sel_hi:[1,0,1] neg_lo:[0,1,0]
    v_cvt_pk_bf16_f32 v5, v26, v27
    ds_write_addtid_b32 v5 offset:3536
    v_pk_mul_f32 v[52:53], v[50:51], v[22:23] op_sel:[0,0] op_sel_hi:[0,1]
    v_pk_fma_f32 v[52:53], v[50:51], v[22:23], v[52:53] op_sel:[1,1,0] op_sel_hi:[1,0,1] neg_lo:[0,1,0]
    v_pk_mul_f32 v[24:25], v[26:27], v[20:21] op_sel:[0,0] op_sel_hi:[0,1]
    v_pk_fma_f32 v[24:25], v[26:27], v[20:21], v[24:25] op_sel:[1,1,0] op_sel_hi:[1,0,1] neg_lo:[0,1,0]
    v_cvt_pk_bf16_f32 v6, v24, v25
    ds_write_addtid_b32 v6 offset:3808
    v_pk_mul_f32 v[54:55], v[50:51], v[50:51] op_sel:[0,0] op_sel_hi:[0,1]
    v_pk_fma_f32 v[54:55], v[50:51], v[50:51], v[54:55] op_sel:[1,1,0] op_sel_hi:[1,0,1] neg_lo:[0,1,0]
    v_pk_mul_f32 v[26:27], v[24:25], v[20:21] op_sel:[0,0] op_sel_hi:[0,1]
    v_pk_fma_f32 v[26:27], v[24:25], v[20:21], v[26:27] op_sel:[1,1,0] op_sel_hi:[1,0,1] neg_lo:[0,1,0]
    v_cvt_pk_bf16_f32 v7, v26, v27
    ds_write_addtid_b32 v7 offset:4080
    v_pk_mul_f32 v[56:57], v[54:55], v[22:23] op_sel:[0,0] op_sel_hi:[0,1]
    v_pk_fma_f32 v[56:57], v[54:55], v[22:23], v[56:57] op_sel:[1,1,0] op_sel_hi:[1,0,1] neg_lo:[0,1,0]
    v_pk_mul_f32 v[24:25], v[26:27], v[20:21] op_sel:[0,0] op_sel_hi:[0,1]
    v_pk_fma_f32 v[24:25], v[26:27], v[20:21], v[24:25] op_sel:[1,1,0] op_sel_hi:[1,0,1] neg_lo:[0,1,0]
    v_cvt_pk_bf16_f32 v4, v24, v25
    ds_write_addtid_b32 v4 offset:4352
    v_pk_mul_f32 v[58:59], v[54:55], v[50:51] op_sel:[0,0] op_sel_hi:[0,1]
    v_pk_fma_f32 v[58:59], v[54:55], v[50:51], v[58:59] op_sel:[1,1,0] op_sel_hi:[1,0,1] neg_lo:[0,1,0]
    v_pk_mul_f32 v[26:27], v[24:25], v[20:21] op_sel:[0,0] op_sel_hi:[0,1]
    v_pk_fma_f32 v[26:27], v[24:25], v[20:21], v[26:27] op_sel:[1,1,0] op_sel_hi:[1,0,1] neg_lo:[0,1,0]
    v_cvt_pk_bf16_f32 v5, v26, v27
    ds_write_addtid_b32 v5 offset:4624
    v_pk_mul_f32 v[60:61], v[58:59], v[22:23] op_sel:[0,0] op_sel_hi:[0,1]
    v_pk_fma_f32 v[60:61], v[58:59], v[22:23], v[60:61] op_sel:[1,1,0] op_sel_hi:[1,0,1] neg_lo:[0,1,0]
    v_pk_mul_f32 v[24:25], v[26:27], v[20:21] op_sel:[0,0] op_sel_hi:[0,1]
    v_pk_fma_f32 v[24:25], v[26:27], v[20:21], v[24:25] op_sel:[1,1,0] op_sel_hi:[1,0,1] neg_lo:[0,1,0]
    v_cvt_pk_bf16_f32 v6, v24, v25
    ds_write_addtid_b32 v6 offset:4896
    v_pk_mul_f32 v[62:63], v[30:31], v[22:23] op_sel:[0,0] op_sel_hi:[0,1]
    v_pk_fma_f32 v[62:63], v[30:31], v[22:23], v[62:63] op_sel:[1,1,0] op_sel_hi:[1,0,1] neg_lo:[0,1,0]
    v_cvt_pk_bf16_f32 v7, v62, -v63
    ds_write_addtid_b32 v7 offset:10880
    v_pk_mul_f32 v[26:27], v[24:25], v[20:21] op_sel:[0,0] op_sel_hi:[0,1]
    v_pk_fma_f32 v[26:27], v[24:25], v[20:21], v[26:27] op_sel:[1,1,0] op_sel_hi:[1,0,1] neg_lo:[0,1,0]
    v_cvt_pk_bf16_f32 v4, v26, v27
    ds_write_addtid_b32 v4 offset:5168
    v_pk_mul_f32 v[28:29], v[34:35], v[22:23] op_sel:[0,0] op_sel_hi:[0,1]
    v_pk_fma_f32 v[28:29], v[34:35], v[22:23], v[28:29] op_sel:[1,1,0] op_sel_hi:[1,0,1] neg_lo:[0,1,0]
    v_cvt_pk_bf16_f32 v5, v28, -v29
    ds_write_addtid_b32 v5 offset:11152
    v_pk_mul_f32 v[24:25], v[26:27], v[20:21] op_sel:[0,0] op_sel_hi:[0,1]
    v_pk_fma_f32 v[24:25], v[26:27], v[20:21], v[24:25] op_sel:[1,1,0] op_sel_hi:[1,0,1] neg_lo:[0,1,0]
    v_cvt_pk_bf16_f32 v6, v24, v25
    ds_write_addtid_b32 v6 offset:5440
    v_pk_mul_f32 v[62:63], v[38:39], v[22:23] op_sel:[0,0] op_sel_hi:[0,1]
    v_pk_fma_f32 v[62:63], v[38:39], v[22:23], v[62:63] op_sel:[1,1,0] op_sel_hi:[1,0,1] neg_lo:[0,1,0]
    v_cvt_pk_bf16_f32 v7, v62, -v63
    ds_write_addtid_b32 v7 offset:11424
    v_pk_mul_f32 v[26:27], v[24:25], v[20:21] op_sel:[0,0] op_sel_hi:[0,1]
    v_pk_fma_f32 v[26:27], v[24:25], v[20:21], v[26:27] op_sel:[1,1,0] op_sel_hi:[1,0,1] neg_lo:[0,1,0]
    v_cvt_pk_bf16_f32 v4, v26, v27
    ds_write_addtid_b32 v4 offset:5712
    v_pk_mul_f32 v[28:29], v[42:43], v[22:23] op_sel:[0,0] op_sel_hi:[0,1]
    v_pk_fma_f32 v[28:29], v[42:43], v[22:23], v[28:29] op_sel:[1,1,0] op_sel_hi:[1,0,1] neg_lo:[0,1,0]
    v_cvt_pk_bf16_f32 v5, v28, -v29
    ds_write_addtid_b32 v5 offset:11696
    v_pk_mul_f32 v[24:25], v[26:27], v[20:21] op_sel:[0,0] op_sel_hi:[0,1]
    v_pk_fma_f32 v[24:25], v[26:27], v[20:21], v[24:25] op_sel:[1,1,0] op_sel_hi:[1,0,1] neg_lo:[0,1,0]
    v_cvt_pk_bf16_f32 v6, v24, v25
    ds_write_addtid_b32 v6 offset:5984
    v_pk_mul_f32 v[62:63], v[46:47], v[22:23] op_sel:[0,0] op_sel_hi:[0,1]
    v_pk_fma_f32 v[62:63], v[46:47], v[22:23], v[62:63] op_sel:[1,1,0] op_sel_hi:[1,0,1] neg_lo:[0,1,0]
    v_cvt_pk_bf16_f32 v7, v62, -v63
    ds_write_addtid_b32 v7 offset:11968
    v_pk_mul_f32 v[26:27], v[24:25], v[20:21] op_sel:[0,0] op_sel_hi:[0,1]
    v_pk_fma_f32 v[26:27], v[24:25], v[20:21], v[26:27] op_sel:[1,1,0] op_sel_hi:[1,0,1] neg_lo:[0,1,0]
    v_cvt_pk_bf16_f32 v4, v26, v27
    ds_write_addtid_b32 v4 offset:6256
    v_pk_mul_f32 v[28:29], v[30:31], v[50:51] op_sel:[0,0] op_sel_hi:[0,1]
    v_pk_fma_f32 v[28:29], v[30:31], v[50:51], v[28:29] op_sel:[1,1,0] op_sel_hi:[1,0,1] neg_lo:[0,1,0]
    v_cvt_pk_bf16_f32 v5, v28, -v29
    ds_write_addtid_b32 v5 offset:12240
    v_pk_mul_f32 v[24:25], v[26:27], v[20:21] op_sel:[0,0] op_sel_hi:[0,1]
    v_pk_fma_f32 v[24:25], v[26:27], v[20:21], v[24:25] op_sel:[1,1,0] op_sel_hi:[1,0,1] neg_lo:[0,1,0]
    v_cvt_pk_bf16_f32 v6, v24, v25
    ds_write_addtid_b32 v6 offset:6528
    v_pk_mul_f32 v[62:63], v[38:39], v[50:51] op_sel:[0,0] op_sel_hi:[0,1]
    v_pk_fma_f32 v[62:63], v[38:39], v[50:51], v[62:63] op_sel:[1,1,0] op_sel_hi:[1,0,1] neg_lo:[0,1,0]
    v_cvt_pk_bf16_f32 v7, v62, -v63
    ds_write_addtid_b32 v7 offset:12512
    v_pk_mul_f32 v[26:27], v[24:25], v[20:21] op_sel:[0,0] op_sel_hi:[0,1]
    v_pk_fma_f32 v[26:27], v[24:25], v[20:21], v[26:27] op_sel:[1,1,0] op_sel_hi:[1,0,1] neg_lo:[0,1,0]
    v_cvt_pk_bf16_f32 v4, v26, v27
    ds_write_addtid_b32 v4 offset:6800
    v_pk_mul_f32 v[28:29], v[46:47], v[50:51] op_sel:[0,0] op_sel_hi:[0,1]
    v_pk_fma_f32 v[28:29], v[46:47], v[50:51], v[28:29] op_sel:[1,1,0] op_sel_hi:[1,0,1] neg_lo:[0,1,0]
    v_cvt_pk_bf16_f32 v5, v28, -v29
    ds_write_addtid_b32 v5 offset:12784
    v_pk_mul_f32 v[24:25], v[26:27], v[20:21] op_sel:[0,0] op_sel_hi:[0,1]
    v_pk_fma_f32 v[24:25], v[26:27], v[20:21], v[24:25] op_sel:[1,1,0] op_sel_hi:[1,0,1] neg_lo:[0,1,0]
    v_cvt_pk_bf16_f32 v6, v24, v25
    ds_write_addtid_b32 v6 offset:7072
    v_pk_mul_f32 v[62:63], v[30:31], v[52:53] op_sel:[0,0] op_sel_hi:[0,1]
    v_pk_fma_f32 v[62:63], v[30:31], v[52:53], v[62:63] op_sel:[1,1,0] op_sel_hi:[1,0,1] neg_lo:[0,1,0]
    v_cvt_pk_bf16_f32 v7, v62, -v63
    ds_write_addtid_b32 v7 offset:13056
    v_pk_mul_f32 v[26:27], v[24:25], v[20:21] op_sel:[0,0] op_sel_hi:[0,1]
    v_pk_fma_f32 v[26:27], v[24:25], v[20:21], v[26:27] op_sel:[1,1,0] op_sel_hi:[1,0,1] neg_lo:[0,1,0]
    v_cvt_pk_bf16_f32 v4, v26, v27
    ds_write_addtid_b32 v4 offset:7344
    v_pk_mul_f32 v[28:29], v[38:39], v[52:53] op_sel:[0,0] op_sel_hi:[0,1]
    v_pk_fma_f32 v[28:29], v[38:39], v[52:53], v[28:29] op_sel:[1,1,0] op_sel_hi:[1,0,1] neg_lo:[0,1,0]
    v_cvt_pk_bf16_f32 v5, v28, -v29
    ds_write_addtid_b32 v5 offset:13328
    v_pk_mul_f32 v[24:25], v[26:27], v[20:21] op_sel:[0,0] op_sel_hi:[0,1]
    v_pk_fma_f32 v[24:25], v[26:27], v[20:21], v[24:25] op_sel:[1,1,0] op_sel_hi:[1,0,1] neg_lo:[0,1,0]
    v_cvt_pk_bf16_f32 v6, v24, v25
    ds_write_addtid_b32 v6 offset:7616
    v_pk_mul_f32 v[62:63], v[46:47], v[52:53] op_sel:[0,0] op_sel_hi:[0,1]
    v_pk_fma_f32 v[62:63], v[46:47], v[52:53], v[62:63] op_sel:[1,1,0] op_sel_hi:[1,0,1] neg_lo:[0,1,0]
    v_cvt_pk_bf16_f32 v7, v62, -v63
    ds_write_addtid_b32 v7 offset:13600
    v_pk_mul_f32 v[26:27], v[24:25], v[20:21] op_sel:[0,0] op_sel_hi:[0,1]
    v_pk_fma_f32 v[26:27], v[24:25], v[20:21], v[26:27] op_sel:[1,1,0] op_sel_hi:[1,0,1] neg_lo:[0,1,0]
    v_cvt_pk_bf16_f32 v4, v26, v27
    ds_write_addtid_b32 v4 offset:7888
    v_pk_mul_f32 v[28:29], v[30:31], v[54:55] op_sel:[0,0] op_sel_hi:[0,1]
    v_pk_fma_f32 v[28:29], v[30:31], v[54:55], v[28:29] op_sel:[1,1,0] op_sel_hi:[1,0,1] neg_lo:[0,1,0]
    v_cvt_pk_bf16_f32 v5, v28, -v29
    ds_write_addtid_b32 v5 offset:13872
    v_pk_mul_f32 v[24:25], v[26:27], v[20:21] op_sel:[0,0] op_sel_hi:[0,1]
    v_pk_fma_f32 v[24:25], v[26:27], v[20:21], v[24:25] op_sel:[1,1,0] op_sel_hi:[1,0,1] neg_lo:[0,1,0]
    v_cvt_pk_bf16_f32 v6, v24, v25
    ds_write_addtid_b32 v6 offset:8160
    v_pk_mul_f32 v[62:63], v[46:47], v[54:55] op_sel:[0,0] op_sel_hi:[0,1]
    v_pk_fma_f32 v[62:63], v[46:47], v[54:55], v[62:63] op_sel:[1,1,0] op_sel_hi:[1,0,1] neg_lo:[0,1,0]
    v_cvt_pk_bf16_f32 v7, v62, -v63
    ds_write_addtid_b32 v7 offset:14144
    v_pk_mul_f32 v[26:27], v[24:25], v[20:21] op_sel:[0,0] op_sel_hi:[0,1]
    v_pk_fma_f32 v[26:27], v[24:25], v[20:21], v[26:27] op_sel:[1,1,0] op_sel_hi:[1,0,1] neg_lo:[0,1,0]
    v_cvt_pk_bf16_f32 v4, v26, v27
    ds_write_addtid_b32 v4 offset:8432
    v_pk_mul_f32 v[28:29], v[30:31], v[56:57] op_sel:[0,0] op_sel_hi:[0,1]
    v_pk_fma_f32 v[28:29], v[30:31], v[56:57], v[28:29] op_sel:[1,1,0] op_sel_hi:[1,0,1] neg_lo:[0,1,0]
    v_cvt_pk_bf16_f32 v5, v28, -v29
    ds_write_addtid_b32 v5 offset:14416
    v_pk_mul_f32 v[62:63], v[46:47], v[56:57] op_sel:[0,0] op_sel_hi:[0,1]
    v_pk_fma_f32 v[62:63], v[46:47], v[56:57], v[62:63] op_sel:[1,1,0] op_sel_hi:[1,0,1] neg_lo:[0,1,0]
    v_cvt_pk_bf16_f32 v6, v62, -v63
    ds_write_addtid_b32 v6 offset:14688
    v_pk_mul_f32 v[28:29], v[30:31], v[58:59] op_sel:[0,0] op_sel_hi:[0,1]
    v_pk_fma_f32 v[28:29], v[30:31], v[58:59], v[28:29] op_sel:[1,1,0] op_sel_hi:[1,0,1] neg_lo:[0,1,0]
    v_cvt_pk_bf16_f32 v7, v28, -v29
    ds_write_addtid_b32 v7 offset:14960
    v_pk_mul_f32 v[62:63], v[46:47], v[58:59] op_sel:[0,0] op_sel_hi:[0,1]
    v_pk_fma_f32 v[62:63], v[46:47], v[58:59], v[62:63] op_sel:[1,1,0] op_sel_hi:[1,0,1] neg_lo:[0,1,0]
    v_cvt_pk_bf16_f32 v4, v62, -v63
    ds_write_addtid_b32 v4 offset:15232
    v_pk_mul_f32 v[28:29], v[30:31], v[60:61] op_sel:[0,0] op_sel_hi:[0,1]
    v_pk_fma_f32 v[28:29], v[30:31], v[60:61], v[28:29] op_sel:[1,1,0] op_sel_hi:[1,0,1] neg_lo:[0,1,0]
    v_cvt_pk_bf16_f32 v5, v28, -v29
    ds_write_addtid_b32 v5 offset:15504
    v_pk_mul_f32 v[62:63], v[46:47], v[60:61] op_sel:[0,0] op_sel_hi:[0,1]
    v_pk_fma_f32 v[62:63], v[46:47], v[60:61], v[62:63] op_sel:[1,1,0] op_sel_hi:[1,0,1] neg_lo:[0,1,0]
    v_cvt_pk_bf16_f32 v6, v62, -v63
    ds_write_addtid_b32 v6 offset:15776
    v_add_u32 v8, s63, v109
    v_add_u32 v9, s63, v108
    s_waitcnt lgkmcnt(0)
    ds_read_b128 v[112:115], v9 offset:0
    ds_read_b128 v[116:119], v8 offset:0
    ds_read_b128 v[120:123], v9 offset:32
    ds_read_b128 v[124:127], v8 offset:32
    ds_read_b128 v[128:131], v9 offset:64
    ds_read_b128 v[132:135], v8 offset:64
    ds_read_b128 v[136:139], v9 offset:96
    ds_read_b128 v[140:143], v8 offset:96
    ds_read_b128 v[144:147], v9 offset:128
    ds_read_b128 v[148:151], v8 offset:128
    ds_read_b128 v[152:155], v9 offset:160
    ds_read_b128 v[156:159], v8 offset:160
    ds_read_b128 v[160:163], v9 offset:192
    ds_read_b128 v[164:167], v8 offset:192
    ds_read_b128 v[168:171], v9 offset:224
    ds_read_b128 v[172:175], v8 offset:224
    s_waitcnt lgkmcnt(14)
    v_mfma_f32_32x32x16_bf16 v[64:79], v[112:115], v[116:119], 0
    s_waitcnt lgkmcnt(12)
    v_mfma_f32_32x32x16_bf16 v[64:79], v[120:123], v[124:127], v[64:79]
    s_waitcnt lgkmcnt(10)
    v_mfma_f32_32x32x16_bf16 v[64:79], v[128:131], v[132:135], v[64:79]
    s_waitcnt lgkmcnt(8)
    v_mfma_f32_32x32x16_bf16 v[64:79], v[136:139], v[140:143], v[64:79]
    s_waitcnt lgkmcnt(6)
    v_mfma_f32_32x32x16_bf16 v[64:79], v[144:147], v[148:151], v[64:79]
    s_waitcnt lgkmcnt(4)
    v_mfma_f32_32x32x16_bf16 v[64:79], v[152:155], v[156:159], v[64:79]
    s_waitcnt lgkmcnt(2)
    v_mfma_f32_32x32x16_bf16 v[64:79], v[160:163], v[164:167], v[64:79]
    s_waitcnt lgkmcnt(0)
    v_mfma_f32_32x32x16_bf16 v[64:79], v[168:171], v[172:175], v[64:79]
    s_lshl_b32 s64, s66, 12
    s_add_u32 s64, s64, 80240
    v_lshl_add_u32 v2, v1, 4, s64
    s_nop 8
    ds_write_b128 v2, v[64:67] offset:0
    ds_write_b128 v2, v[68:71] offset:1024
    ds_write_b128 v2, v[72:75] offset:2048
    ds_write_b128 v2, v[76:79] offset:3072
    s_add_u32 s66, s66, 4
    s_cmp_ge_u32 s66, s67
    s_cbranch_scc1 L_unitdone_24
    s_waitcnt vmcnt(0)
    v_mov_b32 v100, v192
    v_mov_b32 v101, v193
    v_mov_b32 v102, v194
    v_mov_b32 v103, v195
    v_mov_b32 v104, v196
    v_mov_b32 v105, v197
    v_mov_b32 v106, v198
    s_branch L_unit_18
L_unitdone_24:
    s_cmp_eq_u32 s40, 3
    s_cbranch_scc0 L_notA_25
    v_mov_b32 v112, 0
    v_mov_b32 v113, 0
    v_mov_b32 v114, 0
    v_mov_b32 v115, 0
    v_mov_b32 v116, 0
    v_mov_b32 v117, 0
    v_mov_b32 v118, 0
    v_mov_b32 v119, 0
    v_mov_b32 v120, 0
    v_mov_b32 v121, 0
    v_mov_b32 v122, 0
    v_mov_b32 v123, 0
    v_mov_b32 v124, 0
    v_mov_b32 v125, 0
    v_mov_b32 v126, 0
    v_mov_b32 v127, 0
    v_mov_b32 v128, 0
    v_mov_b32 v129, 0
    v_mov_b32 v130, 0
    v_mov_b32 v131, 0
    v_mov_b32 v132, 0
    v_mov_b32 v133, 0
    v_mov_b32 v134, 0
    v_mov_b32 v135, 0
    v_mov_b32 v136, 0
    v_mov_b32 v137, 0
    v_mov_b32 v138, 0
    v_mov_b32 v139, 0
    v_mov_b32 v140, 0
    v_mov_b32 v141, 0
    v_mov_b32 v142, 0
    v_mov_b32 v143, 0
    v_mov_b32 v144, 0
    v_mov_b32 v145, 0
    v_mov_b32 v146, 0
    v_mov_b32 v147, 0
    v_mov_b32 v148, 0
    v_mov_b32 v149, 0
    v_mov_b32 v150, 0
    v_mov_b32 v151, 0
    v_mov_b32 v152, 0
    v_mov_b32 v153, 0
    v_mov_b32 v154, 0
    v_mov_b32 v155, 0
    v_mov_b32 v156, 0
    v_mov_b32 v157, 0
    v_mov_b32 v158, 0
    v_mov_b32 v159, 0
    s_branch L_retA_19
L_notA_25:
    s_waitcnt vmcnt(0)
    v_readfirstlane_b32 s41, v107
    s_nop 0
    s_mul_i32 s41, s41, 0x19660d
    s_add_u32 s41, s41, 0x3c6ef35f
    s_waitcnt lgkmcnt(0)
    s_barrier
    s_barrier
    s_branch L_loader_4
L_teamA_23:
    s_cmp_ge_u32 s40, s47
    s_cbranch_scc1 L_nok_26
    v_add_f32 v64, v16, v32
    v_add_f32 v64, v64, v48
    v_add_f32 v65, v17, v33
    v_add_f32 v65, v65, v49
    v_add_f32 v66, v18, v34
    v_add_f32 v66, v66, v50
    v_add_f32 v67, v19, v35
    v_add_f32 v67, v67, v51
    v_add_f32 v68, v20, v36
    v_add_f32 v68, v68, v52
    v_add_f32 v69, v21, v37
    v_add_f32 v69, v69, v53
    v_add_f32 v70, v22, v38
    v_add_f32 v70, v70, v54
    v_add_f32 v71, v23, v39
    v_add_f32 v71, v71, v55
    v_add_f32 v72, v24, v40
    v_add_f32 v72, v72, v56
    v_add_f32 v73, v25, v41
    v_add_f32 v73, v73, v57
    v_add_f32 v74, v26, v42
    v_add_f32 v74, v74, v58
    v_add_f32 v75, v27, v43
    v_add_f32 v75, v75, v59
    v_add_f32 v76, v28, v44
    v_add_f32 v76, v76, v60
    v_add_f32 v77, v29, v45
    v_add_f32 v77, v77, v61
    v_add_f32 v78, v30, v46
    v_add_f32 v78, v78, v62
    v_add_f32 v79, v31, v47
    v_add_f32 v79, v79, v63
    s_mul_i32 s65, s40, 16640
    s_add_u32 s65, s65, 102400
    s_mov_b32 s64, s65
    v_and_b32 v2, 31, v1
    v_lshrrev_b32 v3, 5, v1
    v_mov_b32 v4, 0
    v_mov_b32 v5, 0
    v_mov_b32 v6, 0
    v_mov_b32 v7, 0
    v_mov_b32 v8, s65
    s_mov_b64 s[58:59], exec
    s_mov_b64 exec, 3
    v_lshl_add_u32 v9, v1, 4, v8
    ds_write_b128 v9, v[4:7]
    s_mov_b64 exec, s[58:59]
    s_add_u32 s65, s65, 32
    v_lshlrev_b32 v4, 4, v2
    v_lshl_add_u32 v4, v3, 3, v4
    v_add_u32 v4, s65, v4
    v_cvt_pk_bf16_f32 v10, v64, v65
    v_cvt_pk_bf16_f32 v11, v66, v67
    ds_write_b64 v4, v[10:11]
    v_cvt_pk_bf16_f32 v12, v68, v68
    v_cvt_pk_bf16_f32 v13, v69, v70
    ds_write_b64 v4, v[12:13] offset:512
    v_lshlrev_b32 v5, 4, v2
    v_add_u32 v5, s65, v5
    v_lshl_add_u32 v6, v3, 9, v5
    v_cvt_pk_bf16_f32 v16, v71, v71
    v_cvt_pk_bf16_f32 v17, v71, v72
    v_cvt_pk_bf16_f32 v18, v72, v72
    v_cvt_pk_bf16_f32 v19, v73, v73
    ds_write_b128 v6, v[16:19] offset:1024
    v_lshl_add_u32 v6, v3, 10, v5
    v_and_b32 v7, 1, v2
    v_cmp_eq_u32 vcc, 1, v7
    s_nop 1
    v_cndmask_b32 v8, v74, v75, vcc
    v_cvt_pk_bf16_f32 v20, v74, v74
    v_mov_b32 v21, v20
    v_cvt_pk_bf16_f32 v22, v8, v75
    v_cvt_pk_bf16_f32 v23, v75, v75
    ds_write_b128 v6, v[20:23] offset:2048
    v_cndmask_b32 v8, v76, v77, vcc
    v_cvt_pk_bf16_f32 v24, v76, v76
    v_mov_b32 v25, v24
    v_cvt_pk_bf16_f32 v26, v8, v77
    v_cvt_pk_bf16_f32 v27, v77, v77
    ds_write_b128 v6, v[24:27] offset:2560
    s_waitcnt lgkmcnt(0)
    v_lshlrev_b32 v10, 4, v1
    v_add_u32 v10, s64, v10
    ds_read_b128 v[160:163], v10 offset:0
    ds_read_b64 v[164:165], v10 offset:16
    ds_read_b128 v[170:173], v10 offset:1024
    ds_read_b64 v[174:175], v10 offset:1040
    ds_read_b128 v[180:183], v10 offset:2048
    ds_read_b64 v[184:185], v10 offset:2064
    ds_read_b128 v[190:193], v10 offset:3072
    ds_read_b64 v[194:195], v10 offset:3088
    s_mov_b64 exec, 7
    ds_read_b128 v[200:203], v10 offset:4096
    ds_read_b64 v[204:205], v10 offset:4112
    s_mov_b64 exec, -1
    s_waitcnt lgkmcnt(8)
    v_alignbyte_b32 v20, v161, v160, 2
    v_alignbyte_b32 v21, v162, v161, 2
    v_alignbyte_b32 v22, v163, v162, 2
    v_alignbyte_b32 v23, v164, v163, 2
    ds_write_b128 v10, v[20:23] offset:4160
    v_alignbyte_b32 v24, v162, v161, 2
    v_alignbyte_b32 v25, v163, v162, 2
    v_alignbyte_b32 v26, v164, v163, 2
    v_alignbyte_b32 v27, v165, v164, 2
    ds_write_b128 v10, v[24:27] offset:12480
    v_mov_b32 v28, v161
    v_mov_b32 v29, v162
    v_mov_b32 v30, v163
    v_mov_b32 v31, v164
    ds_write_b128 v10, v[28:31] offset:8320
    s_waitcnt lgkmcnt(9)
    v_alignbyte_b32 v32, v171, v170, 2
    v_alignbyte_b32 v33, v172, v171, 2
    v_alignbyte_b32 v34, v173, v172, 2
    v_alignbyte_b32 v35, v174, v173, 2
    ds_write_b128 v10, v[32:35] offset:5184
    v_alignbyte_b32 v36, v172, v171, 2
    v_alignbyte_b32 v37, v173, v172, 2
    v_alignbyte_b32 v38, v174, v173, 2
    v_alignbyte_b32 v39, v175, v174, 2
    ds_write_b128 v10, v[36:39] offset:13504
    v_mov_b32 v40, v171
    v_mov_b32 v41, v172
    v_mov_b32 v42, v173
    v_mov_b32 v43, v174
    ds_write_b128 v10, v[40:43] offset:9344
    s_waitcnt lgkmcnt(10)
    v_alignbyte_b32 v20, v181, v180, 2
    v_alignbyte_b32 v21, v182, v181, 2
    v_alignbyte_b32 v22, v183, v182, 2
    v_alignbyte_b32 v23, v184, v183, 2
    ds_write_b128 v10, v[20:23] offset:6208
    v_alignbyte_b32 v24, v182, v181, 2
    v_alignbyte_b32 v25, v183, v182, 2
    v_alignbyte_b32 v26, v184, v183, 2
    v_alignbyte_b32 v27, v185, v184, 2
    ds_write_b128 v10, v[24:27] offset:14528
    v_mov_b32 v28, v181
    v_mov_b32 v29, v182
    v_mov_b32 v30, v183
    v_mov_b32 v31, v184
    ds_write_b128 v10, v[28:31] offset:10368
    s_waitcnt lgkmcnt(11)
    v_alignbyte_b32 v32, v191, v190, 2
    v_alignbyte_b32 v33, v192, v191, 2
    v_alignbyte_b32 v34, v193, v192, 2
    v_alignbyte_b32 v35, v194, v193, 2
    ds_write_b128 v10, v[32:35] offset:7232
    v_alignbyte_b32 v36, v192, v191, 2
    v_alignbyte_b32 v37, v193, v192, 2
    v_alignbyte_b32 v38, v194, v193, 2
    v_alignbyte_b32 v39, v195, v194, 2
    ds_write_b128 v10, v[36:39] offset:15552
    v_mov_b32 v40, v191
    v_mov_b32 v41, v192
    v_mov_b32 v42, v193
    v_mov_b32 v43, v194
    ds_write_b128 v10, v[40:43] offset:11392
    s_mov_b64 exec, 7
    s_waitcnt lgkmcnt(12)
    v_alignbyte_b32 v20, v201, v200, 2
    v_alignbyte_b32 v21, v202, v201, 2
    v_alignbyte_b32 v22, v203, v202, 2
    v_alignbyte_b32 v23, v204, v203, 2
    ds_write_b128 v10, v[20:23] offset:8256
    v_alignbyte_b32 v24, v202, v201, 2
    v_alignbyte_b32 v25, v203, v202, 2
    v_alignbyte_b32 v26, v204, v203, 2
    v_alignbyte_b32 v27, v205, v204, 2
    ds_write_b128 v10, v[24:27] offset:16576
    v_mov_b32 v28, v201
    v_mov_b32 v29, v202
    v_mov_b32 v30, v203
    v_mov_b32 v31, v204
    ds_write_b128 v10, v[28:31] offset:12416
    s_mov_b64 exec, -1
    s_waitcnt lgkmcnt(0)
L_nok_26:
    s_and_b32 s60, s40, 1
    s_lshr_b32 s61, s40, 1
    v_lshlrev_b32 v2, 4, v1
    s_lshl_b32 s56, s60, 12
    v_add_u32 v3, s56, v2
    s_mul_i32 s56, s61, 3072
    s_add_u32 s56, s56, 8192
    v_add_u32 v4, s56, v2
    v_mov_b32 v64, 0
    v_mov_b32 v65, 0
    v_mov_b32 v66, 0
    v_mov_b32 v67, 0
    v_mov_b32 v68, 0
    v_mov_b32 v69, 0
    v_mov_b32 v70, 0
    v_mov_b32 v71, 0
    v_mov_b32 v72, 0
    v_mov_b32 v73, 0
    v_mov_b32 v74, 0
    v_mov_b32 v75, 0
    v_mov_b32 v76, 0
    v_mov_b32 v77, 0
    v_mov_b32 v78, 0
    v_mov_b32 v79, 0
    v_mov_b32 v100, 0
    v_mov_b32 v101, 0
    v_mov_b32 v102, 0
    v_mov_b32 v103, 0
    v_mov_b32 v104, 0
    v_mov_b32 v105, 0
    v_mov_b32 v106, 0
    v_mov_b32 v107, 0
    v_mov_b32 v108, 0
    v_mov_b32 v109, 0
    v_mov_b32 v5, v3
    v_mov_b32 v6, v4
    s_lshl_b32 s65, s2, 7
    s_add_u32 s65, s65, 20086784
    s_waitcnt vmcnt(0)
    v_mov_b32 v52, 163732
    v_mov_b32 v53, 1
    s_mov_b64 s[58:59], exec
    s_mov_b64 exec, 1
    ds_add_rtn_u32 v53, v52, v53
    s_waitcnt lgkmcnt(0)
    v_readfirstlane_b32 s56, v53
    s_nop 0
    s_add_u32 s56, s56, 1
    s_cmp_lg_u32 s56, 4
    s_cbranch_scc1 L_sig_27
    v_mov_b32 v52, 0
    v_mov_b32 v53, s41
    buffer_store_dword v53, v52, s[36:39], s65 offen sc1
L_sig_27:
    s_mov_b64 exec, s[58:59]
    s_barrier
    s_setprio 2
    s_barrier
    ds_read_b128 v[16:19], v6 offset:0
    ds_read_b128 v[8:11], v5 offset:0
    ds_read_b128 v[12:15], v5 offset:2048
    ds_read_b128 v[20:23], v6 offset:1024
    ds_read_b128 v[24:27], v6 offset:2048
    s_mov_b32 s62, 0
    s_mov_b32 s63, 0
L_g1loop_28:
    s_waitcnt lgkmcnt(3)
    v_mfma_f32_32x32x16_bf16 v[64:79], v[16:19], v[8:11], v[64:79]
    ds_read_b128 v[36:39], v6 offset:6144
    s_waitcnt lgkmcnt(3)
    v_mfma_f32_32x32x16_bf16 v[80:95], v[16:19], v[12:15], v[80:95]
    ds_read_b128 v[28:31], v5 offset:1024
    s_add_u32 s63, s63, 20480
    s_cmp_eq_u32 s63, 102400
    s_waitcnt lgkmcnt(3)
    v_mfma_f32_32x32x16_bf16 v[96:111], v[20:23], v[8:11], v[96:111]
    ds_read_b128 v[32:35], v5 offset:3072
    s_cselect_b32 s63, 0, s63
    v_add_u32 v50, s63, v3
    v_mfma_f32_32x32x16_bf16 v[112:127], v[20:23], v[12:15], v[112:127]
    ds_read_b128 v[40:43], v6 offset:7168
    v_add_u32 v51, s63, v4
    s_cmp_eq_u32 s62, 19
    s_waitcnt lgkmcnt(4)
    v_mfma_f32_32x32x16_bf16 v[128:143], v[24:27], v[8:11], v[128:143]
    ds_read_b128 v[44:47], v6 offset:8192
    v_mfma_f32_32x32x16_bf16 v[144:159], v[24:27], v[12:15], v[144:159]
    s_cbranch_scc1 L_g1last_29
    s_waitcnt lgkmcnt(3)
    v_mfma_f32_32x32x16_bf16 v[64:79], v[36:39], v[28:31], v[64:79]
    ds_read_b128 v[16:19], v51 offset:0
    s_waitcnt lgkmcnt(3)
    v_mfma_f32_32x32x16_bf16 v[80:95], v[36:39], v[32:35], v[80:95]
    ds_read_b128 v[8:11], v50 offset:0
    v_mov_b32 v5, v50
    v_mov_b32 v6, v51
    s_waitcnt lgkmcnt(3)
    v_mfma_f32_32x32x16_bf16 v[96:111], v[40:43], v[28:31], v[96:111]
    ds_read_b128 v[12:15], v50 offset:2048
    s_add_u32 s62, s62, 1
    v_mfma_f32_32x32x16_bf16 v[112:127], v[40:43], v[32:35], v[112:127]
    ds_read_b128 v[20:23], v51 offset:1024
    s_waitcnt lgkmcnt(4)
    v_mfma_f32_32x32x16_bf16 v[128:143], v[44:47], v[28:31], v[128:143]
    ds_read_b128 v[24:27], v51 offset:2048
    s_barrier
    v_mfma_f32_32x32x16_bf16 v[144:159], v[44:47], v[32:35], v[144:159]
    s_branch L_g1loop_28
L_g1last_29:
    s_waitcnt lgkmcnt(3)
    v_mfma_f32_32x32x16_bf16 v[64:79], v[36:39], v[28:31], v[64:79]
    s_waitcnt lgkmcnt(2)
    v_mfma_f32_32x32x16_bf16 v[80:95], v[36:39], v[32:35], v[80:95]
    s_waitcnt lgkmcnt(1)
    v_mfma_f32_32x32x16_bf16 v[96:111], v[40:43], v[28:31], v[96:111]
    v_mfma_f32_32x32x16_bf16 v[112:127], v[40:43], v[32:35], v[112:127]
    s_waitcnt lgkmcnt(0)
    v_mfma_f32_32x32x16_bf16 v[128:143], v[44:47], v[28:31], v[128:143]
    s_barrier
    v_mfma_f32_32x32x16_bf16 v[144:159], v[44:47], v[32:35], v[144:159]
    s_setprio 0
    v_and_b32 v8, 15, v1
    v_lshlrev_b32 v8, 4, v8
    v_lshrrev_b32 v9, 5, v1
    v_lshl_add_u32 v8, v9, 8, v8
    v_bfe_u32 v9, v1, 4, 1
    v_mul_u32_u24 v9, 49152, v9
    v_add_u32 v8, v8, v9
    s_lshl_b32 s64, s42, 2
    s_lshl_b32 s65, s60, 1
    s_add_u32 s64, s64, s65
    s_mul_i32 s64, s64, 98304
    s_add_u32 s64, s64, 11141120
    s_mul_i32 s65, s43, 6
    s_mul_i32 s66, s61, 3
    s_add_u32 s65, s65, s66
    s_mov_b32 s68, 0xbfb8aa3b
    s_mov_b32 s69, s68
    s_add_u32 s66, s65, 0
    s_and_b32 s67, s66, 1
    s_lshl_b32 s67, s67, 9
    s_lshr_b32 s66, s66, 1
    s_lshl_b32 s66, s66, 10
    s_add_u32 s66, s66, s67
    s_add_u32 s66, s66, s64
    v_mul_f32 v20, s68, v64
    v_mul_f32 v21, s68, v65
    v_exp_f32 v20, v20
    v_exp_f32 v21, v21
    v_mul_f32 v64, v64, v72
    v_mul_f32 v65, v65, v73
    v_add_f32 v20, 1.0, v20
    v_add_f32 v21, 1.0, v21
    v_rcp_f32 v20, v20
    v_rcp_f32 v21, v21
    v_mul_f32 v64, v64, v20
    v_mul_f32 v65, v65, v21
    v_cvt_pk_bf16_f32 v12, v64, v65
    v_mul_f32 v22, s68, v66
    v_mul_f32 v23, s68, v67
    v_exp_f32 v22, v22
    v_exp_f32 v23, v23
    v_mul_f32 v66, v66, v74
    v_mul_f32 v67, v67, v75
    v_add_f32 v22, 1.0, v22
    v_add_f32 v23, 1.0, v23
    v_rcp_f32 v22, v22
    v_rcp_f32 v23, v23
    v_mul_f32 v66, v66, v22
    v_mul_f32 v67, v67, v23
    v_cvt_pk_bf16_f32 v13, v66, v67
    v_mul_f32 v20, s68, v68
    v_mul_f32 v21, s68, v69
    v_exp_f32 v20, v20
    v_exp_f32 v21, v21
    v_mul_f32 v68, v68, v76
    v_mul_f32 v69, v69, v77
    v_add_f32 v20, 1.0, v20
    v_add_f32 v21, 1.0, v21
    v_rcp_f32 v20, v20
    v_rcp_f32 v21, v21
    v_mul_f32 v68, v68, v20
    v_mul_f32 v69, v69, v21
    v_cvt_pk_bf16_f32 v14, v68, v69
    v_mul_f32 v22, s68, v70
    v_mul_f32 v23, s68, v71
    v_exp_f32 v22, v22
    v_exp_f32 v23, v23
    v_mul_f32 v70, v70, v78
    v_mul_f32 v71, v71, v79
    v_add_f32 v22, 1.0, v22
    v_add_f32 v23, 1.0, v23
    v_rcp_f32 v22, v22
    v_rcp_f32 v23, v23
    v_mul_f32 v70, v70, v22
    v_mul_f32 v71, v71, v23
    v_cvt_pk_bf16_f32 v15, v70, v71
    s_add_u32 s67, s66, 0
    buffer_store_dwordx4 v[12:15], v8, s[36:39], s67 offen sc1
    v_mul_f32 v20, s68, v80
    v_mul_f32 v21, s68, v81
    v_exp_f32 v20, v20
    v_exp_f32 v21, v21
    v_mul_f32 v80, v80, v88
    v_mul_f32 v81, v81, v89
    v_add_f32 v20, 1.0, v20
    v_add_f32 v21, 1.0, v21
    v_rcp_f32 v20, v20
    v_rcp_f32 v21, v21
    v_mul_f32 v80, v80, v20
    v_mul_f32 v81, v81, v21
    v_cvt_pk_bf16_f32 v16, v80, v81
    v_mul_f32 v22, s68, v82
    v_mul_f32 v23, s68, v83
    v_exp_f32 v22, v22
    v_exp_f32 v23, v23
    v_mul_f32 v82, v82, v90
    v_mul_f32 v83, v83, v91
    v_add_f32 v22, 1.0, v22
    v_add_f32 v23, 1.0, v23
    v_rcp_f32 v22, v22
    v_rcp_f32 v23, v23
    v_mul_f32 v82, v82, v22
    v_mul_f32 v83, v83, v23
    v_cvt_pk_bf16_f32 v17, v82, v83
    v_mul_f32 v20, s68, v84
    v_mul_f32 v21, s68, v85
    v_exp_f32 v20, v20
    v_exp_f32 v21, v21
    v_mul_f32 v84, v84, v92
    v_mul_f32 v85, v85, v93
    v_add_f32 v20, 1.0, v20
    v_add_f32 v21, 1.0, v21
    v_rcp_f32 v20, v20
    v_rcp_f32 v21, v21
    v_mul_f32 v84, v84, v20
    v_mul_f32 v85, v85, v21
    v_cvt_pk_bf16_f32 v18, v84, v85
    v_mul_f32 v22, s68, v86
    v_mul_f32 v23, s68, v87
    v_exp_f32 v22, v22
    v_exp_f32 v23, v23
    v_mul_f32 v86, v86, v94
    v_mul_f32 v87, v87, v95
    v_add_f32 v22, 1.0, v22
    v_add_f32 v23, 1.0, v23
    v_rcp_f32 v22, v22
    v_rcp_f32 v23, v23
    v_mul_f32 v86, v86, v22
    v_mul_f32 v87, v87, v23
    v_cvt_pk_bf16_f32 v19, v86, v87
    s_add_u32 s67, s66, 98304
    buffer_store_dwordx4 v[16:19], v8, s[36:39], s67 offen sc1
    s_add_u32 s66, s65, 1
    s_and_b32 s67, s66, 1
    s_lshl_b32 s67, s67, 9
    s_lshr_b32 s66, s66, 1
    s_lshl_b32 s66, s66, 10
    s_add_u32 s66, s66, s67
    s_add_u32 s66, s66, s64
    v_mul_f32 v20, s68, v96
    v_mul_f32 v21, s68, v97
    v_exp_f32 v20, v20
    v_exp_f32 v21, v21
    v_mul_f32 v96, v96, v104
    v_mul_f32 v97, v97, v105
    v_add_f32 v20, 1.0, v20
    v_add_f32 v21, 1.0, v21
    v_rcp_f32 v20, v20
    v_rcp_f32 v21, v21
    v_mul_f32 v96, v96, v20
    v_mul_f32 v97, v97, v21
    v_cvt_pk_bf16_f32 v12, v96, v97
    v_mul_f32 v22, s68, v98
    v_mul_f32 v23, s68, v99
    v_exp_f32 v22, v22
    v_exp_f32 v23, v23
    v_mul_f32 v98, v98, v106
    v_mul_f32 v99, v99, v107
    v_add_f32 v22, 1.0, v22
    v_add_f32 v23, 1.0, v23
    v_rcp_f32 v22, v22
    v_rcp_f32 v23, v23
    v_mul_f32 v98, v98, v22
    v_mul_f32 v99, v99, v23
    v_cvt_pk_bf16_f32 v13, v98, v99
    v_mul_f32 v20, s68, v100
    v_mul_f32 v21, s68, v101
    v_exp_f32 v20, v20
    v_exp_f32 v21, v21
    v_mul_f32 v100, v100, v108
    v_mul_f32 v101, v101, v109
    v_add_f32 v20, 1.0, v20
    v_add_f32 v21, 1.0, v21
    v_rcp_f32 v20, v20
    v_rcp_f32 v21, v21
    v_mul_f32 v100, v100, v20
    v_mul_f32 v101, v101, v21
    v_cvt_pk_bf16_f32 v14, v100, v101
    v_mul_f32 v22, s68, v102
    v_mul_f32 v23, s68, v103
    v_exp_f32 v22, v22
    v_exp_f32 v23, v23
    v_mul_f32 v102, v102, v110
    v_mul_f32 v103, v103, v111
    v_add_f32 v22, 1.0, v22
    v_add_f32 v23, 1.0, v23
    v_rcp_f32 v22, v22
    v_rcp_f32 v23, v23
    v_mul_f32 v102, v102, v22
    v_mul_f32 v103, v103, v23
    v_cvt_pk_bf16_f32 v15, v102, v103
    s_add_u32 s67, s66, 0
    buffer_store_dwordx4 v[12:15], v8, s[36:39], s67 offen sc1
    v_mul_f32 v20, s68, v112
    v_mul_f32 v21, s68, v113
    v_exp_f32 v20, v20
    v_exp_f32 v21, v21
    v_mul_f32 v112, v112, v120
    v_mul_f32 v113, v113, v121
    v_add_f32 v20, 1.0, v20
    v_add_f32 v21, 1.0, v21
    v_rcp_f32 v20, v20
    v_rcp_f32 v21, v21
    v_mul_f32 v112, v112, v20
    v_mul_f32 v113, v113, v21
    v_cvt_pk_bf16_f32 v16, v112, v113
    v_mul_f32 v22, s68, v114
    v_mul_f32 v23, s68, v115
    v_exp_f32 v22, v22
    v_exp_f32 v23, v23
    v_mul_f32 v114, v114, v122
    v_mul_f32 v115, v115, v123
    v_add_f32 v22, 1.0, v22
    v_add_f32 v23, 1.0, v23
    v_rcp_f32 v22, v22
    v_rcp_f32 v23, v23
    v_mul_f32 v114, v114, v22
    v_mul_f32 v115, v115, v23
    v_cvt_pk_bf16_f32 v17, v114, v115
    v_mul_f32 v20, s68, v116
    v_mul_f32 v21, s68, v117
    v_exp_f32 v20, v20
    v_exp_f32 v21, v21
    v_mul_f32 v116, v116, v124
    v_mul_f32 v117, v117, v125
    v_add_f32 v20, 1.0, v20
    v_add_f32 v21, 1.0, v21
    v_rcp_f32 v20, v20
    v_rcp_f32 v21, v21
    v_mul_f32 v116, v116, v20
    v_mul_f32 v117, v117, v21
    v_cvt_pk_bf16_f32 v18, v116, v117
    v_mul_f32 v22, s68, v118
    v_mul_f32 v23, s68, v119
    v_exp_f32 v22, v22
    v_exp_f32 v23, v23
    v_mul_f32 v118, v118, v126
    v_mul_f32 v119, v119, v127
    v_add_f32 v22, 1.0, v22
    v_add_f32 v23, 1.0, v23
    v_rcp_f32 v22, v22
    v_rcp_f32 v23, v23
    v_mul_f32 v118, v118, v22
    v_mul_f32 v119, v119, v23
    v_cvt_pk_bf16_f32 v19, v118, v119
    s_add_u32 s67, s66, 98304
    buffer_store_dwordx4 v[16:19], v8, s[36:39], s67 offen sc1
    s_add_u32 s66, s65, 2
    s_and_b32 s67, s66, 1
    s_lshl_b32 s67, s67, 9
    s_lshr_b32 s66, s66, 1
    s_lshl_b32 s66, s66, 10
    s_add_u32 s66, s66, s67
    s_add_u32 s66, s66, s64
    v_mul_f32 v20, s68, v128
    v_mul_f32 v21, s68, v129
    v_exp_f32 v20, v20
    v_exp_f32 v21, v21
    v_mul_f32 v128, v128, v136
    v_mul_f32 v129, v129, v137
    v_add_f32 v20, 1.0, v20
    v_add_f32 v21, 1.0, v21
    v_rcp_f32 v20, v20
    v_rcp_f32 v21, v21
    v_mul_f32 v128, v128, v20
    v_mul_f32 v129, v129, v21
    v_cvt_pk_bf16_f32 v12, v128, v129
    v_mul_f32 v22, s68, v130
    v_mul_f32 v23, s68, v131
    v_exp_f32 v22, v22
    v_exp_f32 v23, v23
    v_mul_f32 v130, v130, v138
    v_mul_f32 v131, v131, v139
    v_add_f32 v22, 1.0, v22
    v_add_f32 v23, 1.0, v23
    v_rcp_f32 v22, v22
    v_rcp_f32 v23, v23
    v_mul_f32 v130, v130, v22
    v_mul_f32 v131, v131, v23
    v_cvt_pk_bf16_f32 v13, v130, v131
    v_mul_f32 v20, s68, v132
    v_mul_f32 v21, s68, v133
    v_exp_f32 v20, v20
    v_exp_f32 v21, v21
    v_mul_f32 v132, v132, v140
    v_mul_f32 v133, v133, v141
    v_add_f32 v20, 1.0, v20
    v_add_f32 v21, 1.0, v21
    v_rcp_f32 v20, v20
    v_rcp_f32 v21, v21
    v_mul_f32 v132, v132, v20
    v_mul_f32 v133, v133, v21
    v_cvt_pk_bf16_f32 v14, v132, v133
    v_mul_f32 v22, s68, v134
    v_mul_f32 v23, s68, v135
    v_exp_f32 v22, v22
    v_exp_f32 v23, v23
    v_mul_f32 v134, v134, v142
    v_mul_f32 v135, v135, v143
    v_add_f32 v22, 1.0, v22
    v_add_f32 v23, 1.0, v23
    v_rcp_f32 v22, v22
    v_rcp_f32 v23, v23
    v_mul_f32 v134, v134, v22
    v_mul_f32 v135, v135, v23
    v_cvt_pk_bf16_f32 v15, v134, v135
    s_add_u32 s67, s66, 0
    buffer_store_dwordx4 v[12:15], v8, s[36:39], s67 offen sc1
    v_mul_f32 v20, s68, v144
    v_mul_f32 v21, s68, v145
    v_exp_f32 v20, v20
    v_exp_f32 v21, v21
    v_mul_f32 v144, v144, v152
    v_mul_f32 v145, v145, v153
    v_add_f32 v20, 1.0, v20
    v_add_f32 v21, 1.0, v21
    v_rcp_f32 v20, v20
    v_rcp_f32 v21, v21
    v_mul_f32 v144, v144, v20
    v_mul_f32 v145, v145, v21
    v_cvt_pk_bf16_f32 v16, v144, v145
    v_mul_f32 v22, s68, v146
    v_mul_f32 v23, s68, v147
    v_exp_f32 v22, v22
    v_exp_f32 v23, v23
    v_mul_f32 v146, v146, v154
    v_mul_f32 v147, v147, v155
    v_add_f32 v22, 1.0, v22
    v_add_f32 v23, 1.0, v23
    v_rcp_f32 v22, v22
    v_rcp_f32 v23, v23
    v_mul_f32 v146, v146, v22
    v_mul_f32 v147, v147, v23
    v_cvt_pk_bf16_f32 v17, v146, v147
    v_mul_f32 v20, s68, v148
    v_mul_f32 v21, s68, v149
    v_exp_f32 v20, v20
    v_exp_f32 v21, v21
    v_mul_f32 v148, v148, v156
    v_mul_f32 v149, v149, v157
    v_add_f32 v20, 1.0, v20
    v_add_f32 v21, 1.0, v21
    v_rcp_f32 v20, v20
    v_rcp_f32 v21, v21
    v_mul_f32 v148, v148, v20
    v_mul_f32 v149, v149, v21
    v_cvt_pk_bf16_f32 v18, v148, v149
    v_mul_f32 v22, s68, v150
    v_mul_f32 v23, s68, v151
    v_exp_f32 v22, v22
    v_exp_f32 v23, v23
    v_mul_f32 v150, v150, v158
    v_mul_f32 v151, v151, v159
    v_add_f32 v22, 1.0, v22
    v_add_f32 v23, 1.0, v23
    v_rcp_f32 v22, v22
    v_rcp_f32 v23, v23
    v_mul_f32 v150, v150, v22
    v_mul_f32 v151, v151, v23
    v_cvt_pk_bf16_f32 v19, v150, v151
    s_add_u32 s67, s66, 98304
    buffer_store_dwordx4 v[16:19], v8, s[36:39], s67 offen sc1
    s_setprio 0
    v_lshlrev_b32 v2, 4, v1
    s_mul_i32 s60, s40, 12
    s_lshl_b32 s61, s44, 2
    s_mul_i32 s61, s61, 48
    s_add_u32 s61, s61, s60
    s_lshl_b32 s61, s61, 10
    s_add_u32 s61, s61, 11141120
    s_mul_i32 s62, s45, 48
    s_add_u32 s62, s62, s60
    s_mul_i32 s62, s62, 5120
    s_add_u32 s62, s62, 9175040
    s_mov_b32 s63, 0
    s_mov_b32 s64, s63
    s_lshl_b32 s65, s42, 4
    s_add_u32 s65, s65, s43
    s_lshl_b32 s65, s65, 7
    s_add_u32 s65, s65, 20119552
    s_waitcnt vmcnt(0)
    v_mov_b32 v4, 163716
    v_mov_b32 v5, 1
    s_mov_b64 s[58:59], exec
    s_mov_b64 exec, 1
    ds_add_rtn_u32 v5, v4, v5
    s_waitcnt lgkmcnt(0)
    v_readfirstlane_b32 s56, v5
    s_nop 0
    s_add_u32 s56, s56, 1
    s_cmp_lg_u32 s56, 4
    s_cbranch_scc1 L_sig_30
    v_mov_b32 v4, 0
    v_mov_b32 v5, s41
    buffer_store_dword v5, v4, s[36:39], s65 offen sc1
L_sig_30:
    s_mov_b64 exec, s[58:59]
    v_mov_b32 v4, 163724
    s_mov_b32 s57, 0
L_lw_31:
    ds_read_b32 v5, v4
    s_waitcnt lgkmcnt(0)
    v_readfirstlane_b32 s56, v5
    s_nop 0
    s_cmp_eq_u32 s56, 1
    s_cbranch_scc1 L_lwd_32
    s_add_u32 s57, s57, 1
    s_cmp_gt_u32 s57, 262144
    s_cbranch_scc1 L_lwd_32
    s_sleep 1
    s_branch L_lw_31
L_lwd_32:
    s_mul_i32 s66, s64, 5120
    s_add_u32 s66, s66, s62
    buffer_load_dwordx4 v[88:91], v2, s[36:39], s66 offen offset:0 sc1
    buffer_load_dwordx4 v[92:95], v2, s[36:39], s66 offen offset:1024 sc1
    buffer_load_dwordx4 v[96:99], v2, s[36:39], s66 offen offset:2048 sc1
    buffer_load_dwordx4 v[100:103], v2, s[36:39], s66 offen offset:3072 sc1
    s_add_u32 s66, s66, 4096
    buffer_load_dwordx4 v[104:107], v2, s[36:39], s66 offen offset:0 sc1
    s_add_u32 s64, s64, 1
    s_cmp_eq_u32 s64, 12
    s_cselect_b32 s64, 0, s64
    s_mul_i32 s66, s64, 5120
    s_add_u32 s66, s66, s62
    buffer_load_dwordx4 v[108:111], v2, s[36:39], s66 offen offset:0 sc1
    buffer_load_dwordx4 v[112:115], v2, s[36:39], s66 offen offset:1024 sc1
    buffer_load_dwordx4 v[116:119], v2, s[36:39], s66 offen offset:2048 sc1
    buffer_load_dwordx4 v[120:123], v2, s[36:39], s66 offen offset:3072 sc1
    s_add_u32 s66, s66, 4096
    buffer_load_dwordx4 v[124:127], v2, s[36:39], s66 offen offset:0 sc1
    s_add_u32 s64, s64, 1
    s_cmp_eq_u32 s64, 12
    s_cselect_b32 s64, 0, s64
    s_mul_i32 s66, s64, 5120
    s_add_u32 s66, s66, s62
    buffer_load_dwordx4 v[128:131], v2, s[36:39], s66 offen offset:0 sc1
    buffer_load_dwordx4 v[132:135], v2, s[36:39], s66 offen offset:1024 sc1
    buffer_load_dwordx4 v[136:139], v2, s[36:39], s66 offen offset:2048 sc1
    buffer_load_dwordx4 v[140:143], v2, s[36:39], s66 offen offset:3072 sc1
    s_add_u32 s66, s66, 4096
    buffer_load_dwordx4 v[144:147], v2, s[36:39], s66 offen offset:0 sc1
    s_add_u32 s64, s64, 1
    s_cmp_eq_u32 s64, 12
    s_cselect_b32 s64, 0, s64
    s_mul_i32 s66, s64, 5120
    s_add_u32 s66, s66, s62
    buffer_load_dwordx4 v[148:151], v2, s[36:39], s66 offen offset:0 sc1
    buffer_load_dwordx4 v[152:155], v2, s[36:39], s66 offen offset:1024 sc1
    buffer_load_dwordx4 v[156:159], v2, s[36:39], s66 offen offset:2048 sc1
    buffer_load_dwordx4 v[160:163], v2, s[36:39], s66 offen offset:3072 sc1
    s_add_u32 s66, s66, 4096
    buffer_load_dwordx4 v[164:167], v2, s[36:39], s66 offen offset:0 sc1
    s_add_u32 s64, s64, 1
    s_cmp_eq_u32 s64, 12
    s_cselect_b32 s64, 0, s64
    s_mul_i32 s60, s40, 20480
    s_add_u32 s60, s60, 16384
    s_mov_b32 s94, s64
    s_add_u32 s64, s64, 0
    s_cmp_ge_u32 s64, 12
    s_cbranch_scc0 L_nowrap_l0
    s_sub_u32 s64, s64, 12
L_nowrap_l0:
    s_mul_i32 s66, s64, 5120
    s_add_u32 s66, s66, s62
    s_add_u32 m0, s60, 0
    s_nop 0
    buffer_load_dwordx4 v2, s[36:39], s66 offen offset:0 sc1 lds
    s_add_u32 m0, s60, 0
    s_nop 0
    buffer_load_dwordx4 v2, s[36:39], s66 offen offset:1024 sc1 lds
    s_add_u32 m0, s60, 0
    s_nop 0
    buffer_load_dwordx4 v2, s[36:39], s66 offen offset:2048 sc1 lds
    s_add_u32 m0, s60, 0
    s_nop 0
    buffer_load_dwordx4 v2, s[36:39], s66 offen offset:3072 sc1 lds
    s_add_u32 s66, s66, 4096
    s_add_u32 m0, s60, 4096
    s_nop 0
    buffer_load_dwordx4 v2, s[36:39], s66 offen offset:0 sc1 lds
    s_add_u32 s64, s64, 1
    s_cmp_eq_u32 s64, 12
    s_cselect_b32 s64, 0, s64
    s_mul_i32 s66, s64, 5120
    s_add_u32 s66, s66, s62
    s_add_u32 m0, s60, 5120
    s_nop 0
    buffer_load_dwordx4 v2, s[36:39], s66 offen offset:0 sc1 lds
    s_add_u32 m0, s60, 5120
    s_nop 0
    buffer_load_dwordx4 v2, s[36:39], s66 offen offset:1024 sc1 lds
    s_add_u32 m0, s60, 5120
    s_nop 0
    buffer_load_dwordx4 v2, s[36:39], s66 offen offset:2048 sc1 lds
    s_add_u32 m0, s60, 5120
    s_nop 0
    buffer_load_dwordx4 v2, s[36:39], s66 offen offset:3072 sc1 lds
    s_add_u32 s66, s66, 4096
    s_add_u32 m0, s60, 9216
    s_nop 0
    buffer_load_dwordx4 v2, s[36:39], s66 offen offset:0 sc1 lds
    s_add_u32 s64, s64, 1
    s_cmp_eq_u32 s64, 12
    s_cselect_b32 s64, 0, s64
    s_mul_i32 s66, s64, 5120
    s_add_u32 s66, s66, s62
    s_add_u32 m0, s60, 10240
    s_nop 0
    buffer_load_dwordx4 v2, s[36:39], s66 offen offset:0 sc1 lds
    s_add_u32 m0, s60, 10240
    s_nop 0
    buffer_load_dwordx4 v2, s[36:39], s66 offen offset:1024 sc1 lds
    s_add_u32 m0, s60, 10240
    s_nop 0
    buffer_load_dwordx4 v2, s[36:39], s66 offen offset:2048 sc1 lds
    s_add_u32 m0, s60, 10240
    s_nop 0
    buffer_load_dwordx4 v2, s[36:39], s66 offen offset:3072 sc1 lds
    s_add_u32 s66, s66, 4096
    s_add_u32 m0, s60, 14336
    s_nop 0
    buffer_load_dwordx4 v2, s[36:39], s66 offen offset:0 sc1 lds
    s_add_u32 s64, s64, 1
    s_cmp_eq_u32 s64, 12
    s_cselect_b32 s64, 0, s64
    s_mul_i32 s66, s64, 5120
    s_add_u32 s66, s66, s62
    s_add_u32 m0, s60, 15360
    s_nop 0
    buffer_load_dwordx4 v2, s[36:39], s66 offen offset:0 sc1 lds
    s_add_u32 m0, s60, 15360
    s_nop 0
    buffer_load_dwordx4 v2, s[36:39], s66 offen offset:1024 sc1 lds
    s_add_u32 m0, s60, 15360
    s_nop 0
    buffer_load_dwordx4 v2, s[36:39], s66 offen offset:2048 sc1 lds
    s_add_u32 m0, s60, 15360
    s_nop 0
    buffer_load_dwordx4 v2, s[36:39], s66 offen offset:3072 sc1 lds
    s_add_u32 s66, s66, 4096
    s_add_u32 m0, s60, 19456
    s_nop 0
    buffer_load_dwordx4 v2, s[36:39], s66 offen offset:0 sc1 lds
    s_add_u32 s64, s64, 1
    s_cmp_eq_u32 s64, 12
    s_cselect_b32 s64, 0, s64
    s_mov_b32 s95, s64
    s_mov_b32 s64, s94
    v_add_u32 v6, s60, v2
    v_mov_b32 v8, 0
    v_mov_b32 v9, 0
    v_mov_b32 v10, 0
    v_mov_b32 v11, 0
    v_mov_b32 v12, 0
    v_mov_b32 v13, 0
    v_mov_b32 v14, 0
    v_mov_b32 v15, 0
    v_mov_b32 v16, 0
    v_mov_b32 v17, 0
    v_mov_b32 v18, 0
    v_mov_b32 v19, 0
    v_mov_b32 v20, 0
    v_mov_b32 v21, 0
    v_mov_b32 v22, 0
    v_mov_b32 v23, 0
    v_mov_b32 v24, 0
    v_mov_b32 v25, 0
    v_mov_b32 v26, 0
    v_mov_b32 v27, 0
    v_mov_b32 v28, 0
    v_mov_b32 v29, 0
    v_mov_b32 v30, 0
    v_mov_b32 v31, 0
    v_mov_b32 v32, 0
    v_mov_b32 v33, 0
    v_mov_b32 v34, 0
    v_mov_b32 v35, 0
    v_mov_b32 v36, 0
    v_mov_b32 v37, 0
    v_mov_b32 v38, 0
    v_mov_b32 v39, 0
    v_mov_b32 v40, 0
    v_mov_b32 v41, 0
    v_mov_b32 v42, 0
    v_mov_b32 v43, 0
    v_mov_b32 v44, 0
    v_mov_b32 v45, 0
    v_mov_b32 v46, 0
    v_mov_b32 v47, 0
    v_mov_b32 v48, 0
    v_mov_b32 v49, 0
    v_mov_b32 v50, 0
    v_mov_b32 v51, 0
    v_mov_b32 v52, 0
    v_mov_b32 v53, 0
    v_mov_b32 v54, 0
    v_mov_b32 v55, 0
    v_mov_b32 v56, 0
    v_mov_b32 v57, 0
    v_mov_b32 v58, 0
    v_mov_b32 v59, 0
    v_mov_b32 v60, 0
    v_mov_b32 v61, 0
    v_mov_b32 v62, 0
    v_mov_b32 v63, 0
    v_mov_b32 v64, 0
    v_mov_b32 v65, 0
    v_mov_b32 v66, 0
    v_mov_b32 v67, 0
    v_mov_b32 v68, 0
    v_mov_b32 v69, 0
    v_mov_b32 v70, 0
    v_mov_b32 v71, 0
    v_mov_b32 v72, 0
    v_mov_b32 v73, 0
    v_mov_b32 v74, 0
    v_mov_b32 v75, 0
    v_mov_b32 v76, 0
    v_mov_b32 v77, 0
    v_mov_b32 v78, 0
    v_mov_b32 v79, 0
    v_mov_b32 v80, 0
    v_mov_b32 v81, 0
    v_mov_b32 v82, 0
    v_mov_b32 v83, 0
    v_mov_b32 v84, 0
    v_mov_b32 v85, 0
    v_mov_b32 v86, 0
    v_mov_b32 v87, 0
    s_mov_b32 s48, s4
    s_and_b32 s49, s5, 0xffff
    s_mov_b32 s50, 2621440
    s_mov_b32 s51, 0x20000
    s_mov_b32 s52, s30
    s_and_b32 s53, s31, 0xffff
    s_mov_b32 s54, 2621440
    s_mov_b32 s55, 0x20000
    v_and_b32 v3, 15, v1
    v_mul_u32_u24 v248, 1280, v3
    v_lshrrev_b32 v5, 4, v1
    v_lshl_add_u32 v248, v5, 3, v248
    s_lshl_b32 s68, s44, 6
    s_lshl_b32 s69, s40, 4
    s_add_u32 s68, s68, s69
    s_mul_i32 s68, s68, 1280
    s_mul_i32 s69, s45, 160
    s_add_u32 s68, s68, s69
    s_mul_i32 s69, s40, 20480
    v_add_u32 v249, s69, v2
    s_mul_i32 s69, s40, 5120
    v_add_u32 v252, s69, v2
    v_add_u32 v254, 40960, v252
    v_lshrrev_b32 v7, 2, v3
    v_lshl_add_u32 v7, v5, 2, v7
    v_lshlrev_b32 v7, 7, v7
    v_and_b32 v4, 3, v1
    v_lshl_add_u32 v7, v4, 3, v7
    s_lshl_b32 s69, s40, 5
    s_add_u32 s69, s69, 152320
    v_add_u32 v253, s69, v7
    v_mov_b32 v4, 163728
    s_mov_b32 s57, 0
L_lw_33:
    ds_read_b32 v5, v4
    s_waitcnt lgkmcnt(0)
    v_readfirstlane_b32 s56, v5
    s_nop 0
    s_cmp_eq_u32 s56, 1
    s_cbranch_scc1 L_lwd_34
    s_add_u32 s57, s57, 1
    s_cmp_gt_u32 s57, 262144
    s_cbranch_scc1 L_lwd_34
    s_sleep 1
    s_branch L_lw_33
L_lwd_34:
    v_mov_b32 v4, 163748
    s_mov_b32 s57, 0
L_lw_35:
    ds_read_b32 v5, v4
    s_waitcnt lgkmcnt(0)
    v_readfirstlane_b32 s56, v5
    s_nop 0
    s_cmp_eq_u32 s56, s47
    s_cbranch_scc1 L_lwd_36
    s_add_u32 s57, s57, 1
    s_cmp_gt_u32 s57, 262144
    s_cbranch_scc1 L_lwd_36
    s_sleep 1
    s_branch L_lw_35
L_lwd_36:
    s_lshl_b32 s67, s63, 10
    s_add_u32 s67, s67, s61
    buffer_load_dwordx4 v[168:171], v2, s[36:39], s67 offen sc1
    s_add_u32 s67, s67, 49152
    buffer_load_dwordx4 v[172:175], v2, s[36:39], s67 offen sc1
    s_add_u32 s67, s67, 49152
    buffer_load_dwordx4 v[176:179], v2, s[36:39], s67 offen sc1
    s_add_u32 s67, s67, 49152
    buffer_load_dwordx4 v[180:183], v2, s[36:39], s67 offen sc1
    s_add_u32 s63, s63, 1
    s_cmp_eq_u32 s63, 12
    s_cselect_b32 s63, 0, s63
    s_lshl_b32 s67, s63, 10
    s_add_u32 s67, s67, s61
    buffer_load_dwordx4 v[184:187], v2, s[36:39], s67 offen sc1
    s_add_u32 s67, s67, 49152
    buffer_load_dwordx4 v[188:191], v2, s[36:39], s67 offen sc1
    s_add_u32 s67, s67, 49152
    buffer_load_dwordx4 v[192:195], v2, s[36:39], s67 offen sc1
    s_add_u32 s67, s67, 49152
    buffer_load_dwordx4 v[196:199], v2, s[36:39], s67 offen sc1
    s_add_u32 s63, s63, 1
    s_cmp_eq_u32 s63, 12
    s_cselect_b32 s63, 0, s63
    s_lshl_b32 s67, s63, 10
    s_add_u32 s67, s67, s61
    buffer_load_dwordx4 v[200:203], v2, s[36:39], s67 offen sc1
    s_add_u32 s67, s67, 49152
    buffer_load_dwordx4 v[204:207], v2, s[36:39], s67 offen sc1
    s_add_u32 s67, s67, 49152
    buffer_load_dwordx4 v[208:211], v2, s[36:39], s67 offen sc1
    s_add_u32 s67, s67, 49152
    buffer_load_dwordx4 v[212:215], v2, s[36:39], s67 offen sc1
    s_add_u32 s63, s63, 1
    s_cmp_eq_u32 s63, 12
    s_cselect_b32 s63, 0, s63
    s_lshl_b32 s67, s63, 10
    s_add_u32 s67, s67, s61
    buffer_load_dwordx4 v[216:219], v2, s[36:39], s67 offen sc1
    s_add_u32 s67, s67, 49152
    buffer_load_dwordx4 v[220:223], v2, s[36:39], s67 offen sc1
    s_add_u32 s67, s67, 49152
    buffer_load_dwordx4 v[224:227], v2, s[36:39], s67 offen sc1
    s_add_u32 s67, s67, 49152
    buffer_load_dwordx4 v[228:231], v2, s[36:39], s67 offen sc1
    s_add_u32 s63, s63, 1
    s_cmp_eq_u32 s63, 12
    s_cselect_b32 s63, 0, s63
    s_lshl_b32 s67, s63, 10
    s_add_u32 s67, s67, s61
    buffer_load_dwordx4 v[232:235], v2, s[36:39], s67 offen sc1
    s_add_u32 s67, s67, 49152
    buffer_load_dwordx4 v[236:239], v2, s[36:39], s67 offen sc1
    s_add_u32 s67, s67, 49152
    buffer_load_dwordx4 v[240:243], v2, s[36:39], s67 offen sc1
    s_add_u32 s67, s67, 49152
    buffer_load_dwordx4 v[244:247], v2, s[36:39], s67 offen sc1
    s_add_u32 s63, s63, 1
    s_cmp_eq_u32 s63, 12
    s_cselect_b32 s63, 0, s63
    s_waitcnt vmcnt(16)
    v_mfma_f32_16x16x32_bf16 v[8:11], v[88:91], v[168:171], v[8:11]
    v_mfma_f32_16x16x32_bf16 v[12:15], v[88:91], v[172:175], v[12:15]
    v_mfma_f32_16x16x32_bf16 v[16:19], v[88:91], v[176:179], v[16:19]
    v_mfma_f32_16x16x32_bf16 v[20:23], v[88:91], v[180:183], v[20:23]
    v_mfma_f32_16x16x32_bf16 v[24:27], v[92:95], v[168:171], v[24:27]
    v_mfma_f32_16x16x32_bf16 v[28:31], v[92:95], v[172:175], v[28:31]
    v_mfma_f32_16x16x32_bf16 v[32:35], v[92:95], v[176:179], v[32:35]
    v_mfma_f32_16x16x32_bf16 v[36:39], v[92:95], v[180:183], v[36:39]
    v_mfma_f32_16x16x32_bf16 v[40:43], v[96:99], v[168:171], v[40:43]
    v_mfma_f32_16x16x32_bf16 v[44:47], v[96:99], v[172:175], v[44:47]
    v_mfma_f32_16x16x32_bf16 v[48:51], v[96:99], v[176:179], v[48:51]
    v_mfma_f32_16x16x32_bf16 v[52:55], v[96:99], v[180:183], v[52:55]
    v_mfma_f32_16x16x32_bf16 v[56:59], v[100:103], v[168:171], v[56:59]
    v_mfma_f32_16x16x32_bf16 v[60:63], v[100:103], v[172:175], v[60:63]
    v_mfma_f32_16x16x32_bf16 v[64:67], v[100:103], v[176:179], v[64:67]
    v_mfma_f32_16x16x32_bf16 v[68:71], v[100:103], v[180:183], v[68:71]
    v_mfma_f32_16x16x32_bf16 v[72:75], v[104:107], v[168:171], v[72:75]
    v_mfma_f32_16x16x32_bf16 v[76:79], v[104:107], v[172:175], v[76:79]
    v_mfma_f32_16x16x32_bf16 v[80:83], v[104:107], v[176:179], v[80:83]
    v_mfma_f32_16x16x32_bf16 v[84:87], v[104:107], v[180:183], v[84:87]
    s_waitcnt vmcnt(12)
    v_mfma_f32_16x16x32_bf16 v[8:11], v[108:111], v[184:187], v[8:11]
    v_mfma_f32_16x16x32_bf16 v[12:15], v[108:111], v[188:191], v[12:15]
    ds_read_b128 v[88:91], v6 offset:0
    v_mfma_f32_16x16x32_bf16 v[16:19], v[108:111], v[192:195], v[16:19]
    v_mfma_f32_16x16x32_bf16 v[20:23], v[108:111], v[196:199], v[20:23]
    ds_read_b128 v[92:95], v6 offset:1024
    v_mfma_f32_16x16x32_bf16 v[24:27], v[112:115], v[184:187], v[24:27]
    v_mfma_f32_16x16x32_bf16 v[28:31], v[112:115], v[188:191], v[28:31]
    ds_read_b128 v[96:99], v6 offset:2048
    v_mfma_f32_16x16x32_bf16 v[32:35], v[112:115], v[192:195], v[32:35]
    v_mfma_f32_16x16x32_bf16 v[36:39], v[112:115], v[196:199], v[36:39]
    ds_read_b128 v[100:103], v6 offset:3072
    v_mfma_f32_16x16x32_bf16 v[40:43], v[116:119], v[184:187], v[40:43]
    v_mfma_f32_16x16x32_bf16 v[44:47], v[116:119], v[188:191], v[44:47]
    ds_read_b128 v[104:107], v6 offset:4096
    v_mfma_f32_16x16x32_bf16 v[48:51], v[116:119], v[192:195], v[48:51]
    v_mfma_f32_16x16x32_bf16 v[52:55], v[116:119], v[196:199], v[52:55]
    s_lshl_b32 s67, s63, 10
    s_add_u32 s67, s67, s61
    buffer_load_dwordx4 v[168:171], v2, s[36:39], s67 offen sc1
    v_mfma_f32_16x16x32_bf16 v[56:59], v[120:123], v[184:187], v[56:59]
    v_mfma_f32_16x16x32_bf16 v[60:63], v[120:123], v[188:191], v[60:63]
    s_add_u32 s67, s67, 49152
    buffer_load_dwordx4 v[172:175], v2, s[36:39], s67 offen sc1
    v_mfma_f32_16x16x32_bf16 v[64:67], v[120:123], v[192:195], v[64:67]
    v_mfma_f32_16x16x32_bf16 v[68:71], v[120:123], v[196:199], v[68:71]
    s_add_u32 s67, s67, 49152
    buffer_load_dwordx4 v[176:179], v2, s[36:39], s67 offen sc1
    v_mfma_f32_16x16x32_bf16 v[72:75], v[124:127], v[184:187], v[72:75]
    v_mfma_f32_16x16x32_bf16 v[76:79], v[124:127], v[188:191], v[76:79]
    s_add_u32 s67, s67, 49152
    buffer_load_dwordx4 v[180:183], v2, s[36:39], s67 offen sc1
    s_add_u32 s63, s63, 1
    s_cmp_eq_u32 s63, 12
    s_cselect_b32 s63, 0, s63
    v_mfma_f32_16x16x32_bf16 v[80:83], v[124:127], v[192:195], v[80:83]
    v_mfma_f32_16x16x32_bf16 v[84:87], v[124:127], v[196:199], v[84:87]
    s_waitcnt vmcnt(12)
    v_mfma_f32_16x16x32_bf16 v[8:11], v[128:131], v[200:203], v[8:11]
    v_mfma_f32_16x16x32_bf16 v[12:15], v[128:131], v[204:207], v[12:15]
    ds_read_b128 v[108:111], v6 offset:5120
    v_mfma_f32_16x16x32_bf16 v[16:19], v[128:131], v[208:211], v[16:19]
    v_mfma_f32_16x16x32_bf16 v[20:23], v[128:131], v[212:215], v[20:23]
    ds_read_b128 v[112:115], v6 offset:6144
    v_mfma_f32_16x16x32_bf16 v[24:27], v[132:135], v[200:203], v[24:27]
    v_mfma_f32_16x16x32_bf16 v[28:31], v[132:135], v[204:207], v[28:31]
    ds_read_b128 v[116:119], v6 offset:7168
    v_mfma_f32_16x16x32_bf16 v[32:35], v[132:135], v[208:211], v[32:35]
    v_mfma_f32_16x16x32_bf16 v[36:39], v[132:135], v[212:215], v[36:39]
    ds_read_b128 v[120:123], v6 offset:8192
    v_mfma_f32_16x16x32_bf16 v[40:43], v[136:139], v[200:203], v[40:43]
    v_mfma_f32_16x16x32_bf16 v[44:47], v[136:139], v[204:207], v[44:47]
    ds_read_b128 v[124:127], v6 offset:9216
    v_mfma_f32_16x16x32_bf16 v[48:51], v[136:139], v[208:211], v[48:51]
    v_mfma_f32_16x16x32_bf16 v[52:55], v[136:139], v[212:215], v[52:55]
    s_lshl_b32 s67, s63, 10
    s_add_u32 s67, s67, s61
    buffer_load_dwordx4 v[184:187], v2, s[36:39], s67 offen sc1
    v_mfma_f32_16x16x32_bf16 v[56:59], v[140:143], v[200:203], v[56:59]
    v_mfma_f32_16x16x32_bf16 v[60:63], v[140:143], v[204:207], v[60:63]
    s_add_u32 s67, s67, 49152
    buffer_load_dwordx4 v[188:191], v2, s[36:39], s67 offen sc1
    v_mfma_f32_16x16x32_bf16 v[64:67], v[140:143], v[208:211], v[64:67]
    v_mfma_f32_16x16x32_bf16 v[68:71], v[140:143], v[212:215], v[68:71]
    s_add_u32 s67, s67, 49152
    buffer_load_dwordx4 v[192:195], v2, s[36:39], s67 offen sc1
    v_mfma_f32_16x16x32_bf16 v[72:75], v[144:147], v[200:203], v[72:75]
    v_mfma_f32_16x16x32_bf16 v[76:79], v[144:147], v[204:207], v[76:79]
    s_add_u32 s67, s67, 49152
    buffer_load_dwordx4 v[196:199], v2, s[36:39], s67 offen sc1
    s_add_u32 s63, s63, 1
    s_cmp_eq_u32 s63, 12
    s_cselect_b32 s63, 0, s63
    v_mfma_f32_16x16x32_bf16 v[80:83], v[144:147], v[208:211], v[80:83]
    v_mfma_f32_16x16x32_bf16 v[84:87], v[144:147], v[212:215], v[84:87]
    s_waitcnt vmcnt(12)
    v_mfma_f32_16x16x32_bf16 v[8:11], v[148:151], v[216:219], v[8:11]
    v_mfma_f32_16x16x32_bf16 v[12:15], v[148:151], v[220:223], v[12:15]
    ds_read_b128 v[128:131], v6 offset:10240
    v_mfma_f32_16x16x32_bf16 v[16:19], v[148:151], v[224:227], v[16:19]
    v_mfma_f32_16x16x32_bf16 v[20:23], v[148:151], v[228:231], v[20:23]
    ds_read_b128 v[132:135], v6 offset:11264
    v_mfma_f32_16x16x32_bf16 v[24:27], v[152:155], v[216:219], v[24:27]
    v_mfma_f32_16x16x32_bf16 v[28:31], v[152:155], v[220:223], v[28:31]
    ds_read_b128 v[136:139], v6 offset:12288
    v_mfma_f32_16x16x32_bf16 v[32:35], v[152:155], v[224:227], v[32:35]
    v_mfma_f32_16x16x32_bf16 v[36:39], v[152:155], v[228:231], v[36:39]
    ds_read_b128 v[140:143], v6 offset:13312
    v_mfma_f32_16x16x32_bf16 v[40:43], v[156:159], v[216:219], v[40:43]
    v_mfma_f32_16x16x32_bf16 v[44:47], v[156:159], v[220:223], v[44:47]
    ds_read_b128 v[144:147], v6 offset:14336
    v_mfma_f32_16x16x32_bf16 v[48:51], v[156:159], v[224:227], v[48:51]
    v_mfma_f32_16x16x32_bf16 v[52:55], v[156:159], v[228:231], v[52:55]
    s_lshl_b32 s67, s63, 10
    s_add_u32 s67, s67, s61
    buffer_load_dwordx4 v[200:203], v2, s[36:39], s67 offen sc1
    v_mfma_f32_16x16x32_bf16 v[56:59], v[160:163], v[216:219], v[56:59]
    v_mfma_f32_16x16x32_bf16 v[60:63], v[160:163], v[220:223], v[60:63]
    s_add_u32 s67, s67, 49152
    buffer_load_dwordx4 v[204:207], v2, s[36:39], s67 offen sc1
    v_mfma_f32_16x16x32_bf16 v[64:67], v[160:163], v[224:227], v[64:67]
    v_mfma_f32_16x16x32_bf16 v[68:71], v[160:163], v[228:231], v[68:71]
    s_add_u32 s67, s67, 49152
    buffer_load_dwordx4 v[208:211], v2, s[36:39], s67 offen sc1
    v_mfma_f32_16x16x32_bf16 v[72:75], v[164:167], v[216:219], v[72:75]
    v_mfma_f32_16x16x32_bf16 v[76:79], v[164:167], v[220:223], v[76:79]
    s_add_u32 s67, s67, 49152
    buffer_load_dwordx4 v[212:215], v2, s[36:39], s67 offen sc1
    s_add_u32 s63, s63, 1
    s_cmp_eq_u32 s63, 12
    s_cselect_b32 s63, 0, s63
    v_mfma_f32_16x16x32_bf16 v[80:83], v[164:167], v[224:227], v[80:83]
    v_mfma_f32_16x16x32_bf16 v[84:87], v[164:167], v[228:231], v[84:87]
    s_waitcnt vmcnt(12)
    s_waitcnt lgkmcnt(0)
    v_mfma_f32_16x16x32_bf16 v[8:11], v[88:91], v[232:235], v[8:11]
    v_mfma_f32_16x16x32_bf16 v[12:15], v[88:91], v[236:239], v[12:15]
    ds_read_b128 v[148:151], v6 offset:15360
    v_mfma_f32_16x16x32_bf16 v[16:19], v[88:91], v[240:243], v[16:19]
    v_mfma_f32_16x16x32_bf16 v[20:23], v[88:91], v[244:247], v[20:23]
    ds_read_b128 v[152:155], v6 offset:16384
    v_mfma_f32_16x16x32_bf16 v[24:27], v[92:95], v[232:235], v[24:27]
    v_mfma_f32_16x16x32_bf16 v[28:31], v[92:95], v[236:239], v[28:31]
    ds_read_b128 v[156:159], v6 offset:17408
    v_mfma_f32_16x16x32_bf16 v[32:35], v[92:95], v[240:243], v[32:35]
    v_mfma_f32_16x16x32_bf16 v[36:39], v[92:95], v[244:247], v[36:39]
    ds_read_b128 v[160:163], v6 offset:18432
    v_mfma_f32_16x16x32_bf16 v[40:43], v[96:99], v[232:235], v[40:43]
    v_mfma_f32_16x16x32_bf16 v[44:47], v[96:99], v[236:239], v[44:47]
    ds_read_b128 v[164:167], v6 offset:19456
    v_mfma_f32_16x16x32_bf16 v[48:51], v[96:99], v[240:243], v[48:51]
    v_mfma_f32_16x16x32_bf16 v[52:55], v[96:99], v[244:247], v[52:55]
    s_lshl_b32 s67, s63, 10
    s_add_u32 s67, s67, s61
    buffer_load_dwordx4 v[216:219], v2, s[36:39], s67 offen sc1
    v_mfma_f32_16x16x32_bf16 v[56:59], v[100:103], v[232:235], v[56:59]
    v_mfma_f32_16x16x32_bf16 v[60:63], v[100:103], v[236:239], v[60:63]
    s_add_u32 s67, s67, 49152
    buffer_load_dwordx4 v[220:223], v2, s[36:39], s67 offen sc1
    v_mfma_f32_16x16x32_bf16 v[64:67], v[100:103], v[240:243], v[64:67]
    v_mfma_f32_16x16x32_bf16 v[68:71], v[100:103], v[244:247], v[68:71]
    s_add_u32 s67, s67, 49152
    buffer_load_dwordx4 v[224:227], v2, s[36:39], s67 offen sc1
    v_mfma_f32_16x16x32_bf16 v[72:75], v[104:107], v[232:235], v[72:75]
    v_mfma_f32_16x16x32_bf16 v[76:79], v[104:107], v[236:239], v[76:79]
    s_add_u32 s67, s67, 49152
    buffer_load_dwordx4 v[228:231], v2, s[36:39], s67 offen sc1
    s_add_u32 s63, s63, 1
    s_cmp_eq_u32 s63, 12
    s_cselect_b32 s63, 0, s63
    v_mfma_f32_16x16x32_bf16 v[80:83], v[104:107], v[240:243], v[80:83]
    v_mfma_f32_16x16x32_bf16 v[84:87], v[104:107], v[244:247], v[84:87]
    s_waitcnt vmcnt(12)
    s_waitcnt lgkmcnt(0)
    s_mov_b32 s64, s95
    v_mfma_f32_16x16x32_bf16 v[8:11], v[108:111], v[168:171], v[8:11]
    v_mfma_f32_16x16x32_bf16 v[12:15], v[108:111], v[172:175], v[12:15]
    s_mul_i32 s66, s64, 5120
    s_add_u32 s66, s66, s62
    buffer_load_dwordx4 v[88:91], v2, s[36:39], s66 offen offset:0 sc1
    v_mfma_f32_16x16x32_bf16 v[16:19], v[108:111], v[176:179], v[16:19]
    v_mfma_f32_16x16x32_bf16 v[20:23], v[108:111], v[180:183], v[20:23]
    buffer_load_dwordx4 v[92:95], v2, s[36:39], s66 offen offset:1024 sc1
    v_mfma_f32_16x16x32_bf16 v[24:27], v[112:115], v[168:171], v[24:27]
    v_mfma_f32_16x16x32_bf16 v[28:31], v[112:115], v[172:175], v[28:31]
    buffer_load_dwordx4 v[96:99], v2, s[36:39], s66 offen offset:2048 sc1
    v_mfma_f32_16x16x32_bf16 v[32:35], v[112:115], v[176:179], v[32:35]
    v_mfma_f32_16x16x32_bf16 v[36:39], v[112:115], v[180:183], v[36:39]
    buffer_load_dwordx4 v[100:103], v2, s[36:39], s66 offen offset:3072 sc1
    v_mfma_f32_16x16x32_bf16 v[40:43], v[116:119], v[168:171], v[40:43]
    v_mfma_f32_16x16x32_bf16 v[44:47], v[116:119], v[172:175], v[44:47]
    s_add_u32 s66, s66, 4096
    buffer_load_dwordx4 v[104:107], v2, s[36:39], s66 offen offset:0 sc1
    s_add_u32 s64, s64, 1
    s_cmp_eq_u32 s64, 12
    s_cselect_b32 s64, 0, s64
    v_mfma_f32_16x16x32_bf16 v[48:51], v[116:119], v[176:179], v[48:51]
    v_mfma_f32_16x16x32_bf16 v[52:55], v[116:119], v[180:183], v[52:55]
    s_lshl_b32 s67, s63, 10
    s_add_u32 s67, s67, s61
    buffer_load_dwordx4 v[232:235], v2, s[36:39], s67 offen sc1
    v_mfma_f32_16x16x32_bf16 v[56:59], v[120:123], v[168:171], v[56:59]
    v_mfma_f32_16x16x32_bf16 v[60:63], v[120:123], v[172:175], v[60:63]
    s_add_u32 s67, s67, 49152
    buffer_load_dwordx4 v[236:239], v2, s[36:39], s67 offen sc1
    v_mfma_f32_16x16x32_bf16 v[64:67], v[120:123], v[176:179], v[64:67]
    v_mfma_f32_16x16x32_bf16 v[68:71], v[120:123], v[180:183], v[68:71]
    s_add_u32 s67, s67, 49152
    buffer_load_dwordx4 v[240:243], v2, s[36:39], s67 offen sc1
    v_mfma_f32_16x16x32_bf16 v[72:75], v[124:127], v[168:171], v[72:75]
    v_mfma_f32_16x16x32_bf16 v[76:79], v[124:127], v[172:175], v[76:79]
    s_add_u32 s67, s67, 49152
    buffer_load_dwordx4 v[244:247], v2, s[36:39], s67 offen sc1
    s_add_u32 s63, s63, 1
    s_cmp_eq_u32 s63, 12
    s_cselect_b32 s63, 0, s63
    v_mfma_f32_16x16x32_bf16 v[80:83], v[124:127], v[176:179], v[80:83]
    v_mfma_f32_16x16x32_bf16 v[84:87], v[124:127], v[180:183], v[84:87]
    s_waitcnt vmcnt(17)
    s_waitcnt lgkmcnt(0)
    v_mfma_f32_16x16x32_bf16 v[8:11], v[128:131], v[184:187], v[8:11]
    v_mfma_f32_16x16x32_bf16 v[12:15], v[128:131], v[188:191], v[12:15]
    s_mul_i32 s66, s64, 5120
    s_add_u32 s66, s66, s62
    buffer_load_dwordx4 v[108:111], v2, s[36:39], s66 offen offset:0 sc1
    v_mfma_f32_16x16x32_bf16 v[16:19], v[128:131], v[192:195], v[16:19]
    v_mfma_f32_16x16x32_bf16 v[20:23], v[128:131], v[196:199], v[20:23]
    buffer_load_dwordx4 v[112:115], v2, s[36:39], s66 offen offset:1024 sc1
    v_mfma_f32_16x16x32_bf16 v[24:27], v[132:135], v[184:187], v[24:27]
    v_mfma_f32_16x16x32_bf16 v[28:31], v[132:135], v[188:191], v[28:31]
    buffer_load_dwordx4 v[116:119], v2, s[36:39], s66 offen offset:2048 sc1
    v_mfma_f32_16x16x32_bf16 v[32:35], v[132:135], v[192:195], v[32:35]
    v_mfma_f32_16x16x32_bf16 v[36:39], v[132:135], v[196:199], v[36:39]
    buffer_load_dwordx4 v[120:123], v2, s[36:39], s66 offen offset:3072 sc1
    v_mfma_f32_16x16x32_bf16 v[40:43], v[136:139], v[184:187], v[40:43]
    v_mfma_f32_16x16x32_bf16 v[44:47], v[136:139], v[188:191], v[44:47]
    s_add_u32 s66, s66, 4096
    buffer_load_dwordx4 v[124:127], v2, s[36:39], s66 offen offset:0 sc1
    s_add_u32 s64, s64, 1
    s_cmp_eq_u32 s64, 12
    s_cselect_b32 s64, 0, s64
    v_mfma_f32_16x16x32_bf16 v[48:51], v[136:139], v[192:195], v[48:51]
    v_mfma_f32_16x16x32_bf16 v[52:55], v[136:139], v[196:199], v[52:55]
    s_lshl_b32 s67, s63, 10
    s_add_u32 s67, s67, s61
    buffer_load_dwordx4 v[168:171], v2, s[36:39], s67 offen sc1
    v_mfma_f32_16x16x32_bf16 v[56:59], v[140:143], v[184:187], v[56:59]
    v_mfma_f32_16x16x32_bf16 v[60:63], v[140:143], v[188:191], v[60:63]
    s_add_u32 s67, s67, 49152
    buffer_load_dwordx4 v[172:175], v2, s[36:39], s67 offen sc1
    v_mfma_f32_16x16x32_bf16 v[64:67], v[140:143], v[192:195], v[64:67]
    v_mfma_f32_16x16x32_bf16 v[68:71], v[140:143], v[196:199], v[68:71]
    s_add_u32 s67, s67, 49152
    buffer_load_dwordx4 v[176:179], v2, s[36:39], s67 offen sc1
    v_mfma_f32_16x16x32_bf16 v[72:75], v[144:147], v[184:187], v[72:75]
    v_mfma_f32_16x16x32_bf16 v[76:79], v[144:147], v[188:191], v[76:79]
    s_add_u32 s67, s67, 49152
    buffer_load_dwordx4 v[180:183], v2, s[36:39], s67 offen sc1
    s_add_u32 s63, s63, 1
    s_cmp_eq_u32 s63, 12
    s_cselect_b32 s63, 0, s63
    v_mfma_f32_16x16x32_bf16 v[80:83], v[144:147], v[192:195], v[80:83]
    v_mfma_f32_16x16x32_bf16 v[84:87], v[144:147], v[196:199], v[84:87]
    s_waitcnt vmcnt(22)
    s_waitcnt lgkmcnt(0)
    v_mov_b32 v4, 163740
    v_mov_b32 v5, 1
    s_mov_b64 exec, 1
    ds_add_u32 v4, v5
    s_mov_b64 exec, -1
    v_mfma_f32_16x16x32_bf16 v[8:11], v[148:151], v[200:203], v[8:11]
    v_mfma_f32_16x16x32_bf16 v[12:15], v[148:151], v[204:207], v[12:15]
    s_mul_i32 s66, s64, 5120
    s_add_u32 s66, s66, s62
    buffer_load_dwordx4 v[128:131], v2, s[36:39], s66 offen offset:0 sc1
    v_mfma_f32_16x16x32_bf16 v[16:19], v[148:151], v[208:211], v[16:19]
    v_mfma_f32_16x16x32_bf16 v[20:23], v[148:151], v[212:215], v[20:23]
    buffer_load_dwordx4 v[132:135], v2, s[36:39], s66 offen offset:1024 sc1
    v_mfma_f32_16x16x32_bf16 v[24:27], v[152:155], v[200:203], v[24:27]
    v_mfma_f32_16x16x32_bf16 v[28:31], v[152:155], v[204:207], v[28:31]
    buffer_load_dwordx4 v[136:139], v2, s[36:39], s66 offen offset:2048 sc1
    v_mfma_f32_16x16x32_bf16 v[32:35], v[152:155], v[208:211], v[32:35]
    v_mfma_f32_16x16x32_bf16 v[36:39], v[152:155], v[212:215], v[36:39]
    buffer_load_dwordx4 v[140:143], v2, s[36:39], s66 offen offset:3072 sc1
    v_mfma_f32_16x16x32_bf16 v[40:43], v[156:159], v[200:203], v[40:43]
    v_mfma_f32_16x16x32_bf16 v[44:47], v[156:159], v[204:207], v[44:47]
    s_add_u32 s66, s66, 4096
    buffer_load_dwordx4 v[144:147], v2, s[36:39], s66 offen offset:0 sc1
    s_add_u32 s64, s64, 1
    s_cmp_eq_u32 s64, 12
    s_cselect_b32 s64, 0, s64
    v_mfma_f32_16x16x32_bf16 v[48:51], v[156:159], v[208:211], v[48:51]
    v_mfma_f32_16x16x32_bf16 v[52:55], v[156:159], v[212:215], v[52:55]
    s_lshl_b32 s67, s63, 10
    s_add_u32 s67, s67, s61
    buffer_load_dwordx4 v[184:187], v2, s[36:39], s67 offen sc1
    v_mfma_f32_16x16x32_bf16 v[56:59], v[160:163], v[200:203], v[56:59]
    v_mfma_f32_16x16x32_bf16 v[60:63], v[160:163], v[204:207], v[60:63]
    s_add_u32 s67, s67, 49152
    buffer_load_dwordx4 v[188:191], v2, s[36:39], s67 offen sc1
    v_mfma_f32_16x16x32_bf16 v[64:67], v[160:163], v[208:211], v[64:67]
    v_mfma_f32_16x16x32_bf16 v[68:71], v[160:163], v[212:215], v[68:71]
    s_add_u32 s67, s67, 49152
    buffer_load_dwordx4 v[192:195], v2, s[36:39], s67 offen sc1
    v_mfma_f32_16x16x32_bf16 v[72:75], v[164:167], v[200:203], v[72:75]
    v_mfma_f32_16x16x32_bf16 v[76:79], v[164:167], v[204:207], v[76:79]
    s_add_u32 s67, s67, 49152
    buffer_load_dwordx4 v[196:199], v2, s[36:39], s67 offen sc1
    s_add_u32 s63, s63, 1
    s_cmp_eq_u32 s63, 12
    s_cselect_b32 s63, 0, s63
    v_mfma_f32_16x16x32_bf16 v[80:83], v[164:167], v[208:211], v[80:83]
    v_mfma_f32_16x16x32_bf16 v[84:87], v[164:167], v[212:215], v[84:87]
    s_waitcnt vmcnt(22)
    v_mfma_f32_16x16x32_bf16 v[8:11], v[88:91], v[216:219], v[8:11]
    v_mfma_f32_16x16x32_bf16 v[12:15], v[88:91], v[220:223], v[12:15]
    s_mul_i32 s66, s64, 5120
    s_add_u32 s66, s66, s62
    buffer_load_dwordx4 v[148:151], v2, s[36:39], s66 offen offset:0 sc1
    v_mfma_f32_16x16x32_bf16 v[16:19], v[88:91], v[224:227], v[16:19]
    v_mfma_f32_16x16x32_bf16 v[20:23], v[88:91], v[228:231], v[20:23]
    buffer_load_dwordx4 v[152:155], v2, s[36:39], s66 offen offset:1024 sc1
    v_mfma_f32_16x16x32_bf16 v[24:27], v[92:95], v[216:219], v[24:27]
    v_mfma_f32_16x16x32_bf16 v[28:31], v[92:95], v[220:223], v[28:31]
    buffer_load_dwordx4 v[156:159], v2, s[36:39], s66 offen offset:2048 sc1
    v_mfma_f32_16x16x32_bf16 v[32:35], v[92:95], v[224:227], v[32:35]
    v_mfma_f32_16x16x32_bf16 v[36:39], v[92:95], v[228:231], v[36:39]
    buffer_load_dwordx4 v[160:163], v2, s[36:39], s66 offen offset:3072 sc1
    v_mfma_f32_16x16x32_bf16 v[40:43], v[96:99], v[216:219], v[40:43]
    v_mfma_f32_16x16x32_bf16 v[44:47], v[96:99], v[220:223], v[44:47]
    s_add_u32 s66, s66, 4096
    buffer_load_dwordx4 v[164:167], v2, s[36:39], s66 offen offset:0 sc1
    s_add_u32 s64, s64, 1
    s_cmp_eq_u32 s64, 12
    s_cselect_b32 s64, 0, s64
    v_mfma_f32_16x16x32_bf16 v[48:51], v[96:99], v[224:227], v[48:51]
    v_mfma_f32_16x16x32_bf16 v[52:55], v[96:99], v[228:231], v[52:55]
    v_mfma_f32_16x16x32_bf16 v[56:59], v[100:103], v[216:219], v[56:59]
    v_mfma_f32_16x16x32_bf16 v[60:63], v[100:103], v[220:223], v[60:63]
    v_mfma_f32_16x16x32_bf16 v[64:67], v[100:103], v[224:227], v[64:67]
    v_mfma_f32_16x16x32_bf16 v[68:71], v[100:103], v[228:231], v[68:71]
    v_mfma_f32_16x16x32_bf16 v[72:75], v[104:107], v[216:219], v[72:75]
    v_mfma_f32_16x16x32_bf16 v[76:79], v[104:107], v[220:223], v[76:79]
    v_mfma_f32_16x16x32_bf16 v[80:83], v[104:107], v[224:227], v[80:83]
    v_mfma_f32_16x16x32_bf16 v[84:87], v[104:107], v[228:231], v[84:87]
    s_waitcnt vmcnt(18)
    v_mfma_f32_16x16x32_bf16 v[8:11], v[108:111], v[232:235], v[8:11]
    v_mfma_f32_16x16x32_bf16 v[12:15], v[108:111], v[236:239], v[12:15]
    buffer_load_dwordx2 v[216:217], v248, s[48:51], s68 offen offset:0
    v_mfma_f32_16x16x32_bf16 v[16:19], v[108:111], v[240:243], v[16:19]
    v_mfma_f32_16x16x32_bf16 v[20:23], v[108:111], v[244:247], v[20:23]
    buffer_load_dwordx2 v[218:219], v248, s[48:51], s68 offen offset:32
    v_mfma_f32_16x16x32_bf16 v[24:27], v[112:115], v[232:235], v[24:27]
    v_mfma_f32_16x16x32_bf16 v[28:31], v[112:115], v[236:239], v[28:31]
    buffer_load_dwordx2 v[220:221], v248, s[48:51], s68 offen offset:64
    v_mfma_f32_16x16x32_bf16 v[32:35], v[112:115], v[240:243], v[32:35]
    v_mfma_f32_16x16x32_bf16 v[36:39], v[112:115], v[244:247], v[36:39]
    buffer_load_dwordx2 v[222:223], v248, s[48:51], s68 offen offset:96
    v_mfma_f32_16x16x32_bf16 v[40:43], v[116:119], v[232:235], v[40:43]
    v_mfma_f32_16x16x32_bf16 v[44:47], v[116:119], v[236:239], v[44:47]
    buffer_load_dwordx2 v[224:225], v248, s[48:51], s68 offen offset:128
    v_mfma_f32_16x16x32_bf16 v[48:51], v[116:119], v[240:243], v[48:51]
    v_mfma_f32_16x16x32_bf16 v[52:55], v[116:119], v[244:247], v[52:55]
    v_mfma_f32_16x16x32_bf16 v[56:59], v[120:123], v[232:235], v[56:59]
    v_mfma_f32_16x16x32_bf16 v[60:63], v[120:123], v[236:239], v[60:63]
    v_mfma_f32_16x16x32_bf16 v[64:67], v[120:123], v[240:243], v[64:67]
    v_mfma_f32_16x16x32_bf16 v[68:71], v[120:123], v[244:247], v[68:71]
    v_mfma_f32_16x16x32_bf16 v[72:75], v[124:127], v[232:235], v[72:75]
    v_mfma_f32_16x16x32_bf16 v[76:79], v[124:127], v[236:239], v[76:79]
    v_mfma_f32_16x16x32_bf16 v[80:83], v[124:127], v[240:243], v[80:83]
    v_mfma_f32_16x16x32_bf16 v[84:87], v[124:127], v[244:247], v[84:87]
    s_waitcnt vmcnt(14)
    v_mfma_f32_16x16x32_bf16 v[8:11], v[128:131], v[168:171], v[8:11]
    v_mfma_f32_16x16x32_bf16 v[12:15], v[128:131], v[172:175], v[12:15]
    v_mfma_f32_16x16x32_bf16 v[16:19], v[128:131], v[176:179], v[16:19]
    v_mfma_f32_16x16x32_bf16 v[20:23], v[128:131], v[180:183], v[20:23]
    v_mfma_f32_16x16x32_bf16 v[24:27], v[132:135], v[168:171], v[24:27]
    v_mfma_f32_16x16x32_bf16 v[28:31], v[132:135], v[172:175], v[28:31]
    v_mfma_f32_16x16x32_bf16 v[32:35], v[132:135], v[176:179], v[32:35]
    v_mfma_f32_16x16x32_bf16 v[36:39], v[132:135], v[180:183], v[36:39]
    v_mfma_f32_16x16x32_bf16 v[40:43], v[136:139], v[168:171], v[40:43]
    v_mfma_f32_16x16x32_bf16 v[44:47], v[136:139], v[172:175], v[44:47]
    v_mfma_f32_16x16x32_bf16 v[48:51], v[136:139], v[176:179], v[48:51]
    v_mfma_f32_16x16x32_bf16 v[52:55], v[136:139], v[180:183], v[52:55]
    v_mfma_f32_16x16x32_bf16 v[56:59], v[140:143], v[168:171], v[56:59]
    v_mfma_f32_16x16x32_bf16 v[60:63], v[140:143], v[172:175], v[60:63]
    v_mfma_f32_16x16x32_bf16 v[64:67], v[140:143], v[176:179], v[64:67]
    v_mfma_f32_16x16x32_bf16 v[68:71], v[140:143], v[180:183], v[68:71]
    v_mfma_f32_16x16x32_bf16 v[72:75], v[144:147], v[168:171], v[72:75]
    v_mfma_f32_16x16x32_bf16 v[76:79], v[144:147], v[172:175], v[76:79]
    v_mfma_f32_16x16x32_bf16 v[80:83], v[144:147], v[176:179], v[80:83]
    v_mfma_f32_16x16x32_bf16 v[84:87], v[144:147], v[180:183], v[84:87]
    s_waitcnt vmcnt(5)
    v_mov_b32 v4, 163740
    s_mov_b32 s57, 0
L_lw_37:
    ds_read_b32 v5, v4
    s_waitcnt lgkmcnt(0)
    v_readfirstlane_b32 s56, v5
    s_nop 0
    s_cmp_eq_u32 s56, 4
    s_cbranch_scc1 L_lwd_38
    s_add_u32 s57, s57, 1
    s_cmp_gt_u32 s57, 262144
    s_cbranch_scc1 L_lwd_38
    s_sleep 1
    s_branch L_lw_37
L_lwd_38:
    v_mfma_f32_16x16x32_bf16 v[8:11], v[148:151], v[184:187], v[8:11]
    v_mfma_f32_16x16x32_bf16 v[12:15], v[148:151], v[188:191], v[12:15]
    v_mfma_f32_16x16x32_bf16 v[16:19], v[148:151], v[192:195], v[16:19]
    v_mfma_f32_16x16x32_bf16 v[20:23], v[148:151], v[196:199], v[20:23]
    v_mfma_f32_16x16x32_bf16 v[24:27], v[152:155], v[184:187], v[24:27]
    v_mfma_f32_16x16x32_bf16 v[28:31], v[152:155], v[188:191], v[28:31]
    v_mfma_f32_16x16x32_bf16 v[32:35], v[152:155], v[192:195], v[32:35]
    v_mfma_f32_16x16x32_bf16 v[36:39], v[152:155], v[196:199], v[36:39]
    v_mfma_f32_16x16x32_bf16 v[40:43], v[156:159], v[184:187], v[40:43]
    v_mfma_f32_16x16x32_bf16 v[44:47], v[156:159], v[188:191], v[44:47]
    v_mfma_f32_16x16x32_bf16 v[48:51], v[156:159], v[192:195], v[48:51]
    v_mfma_f32_16x16x32_bf16 v[52:55], v[156:159], v[196:199], v[52:55]
    ds_write_b128 v249, v[8:11] offset:0
    ds_write_b128 v249, v[12:15] offset:5120
    ds_write_b128 v249, v[16:19] offset:10240
    ds_write_b128 v249, v[20:23] offset:15360
    v_mfma_f32_16x16x32_bf16 v[56:59], v[160:163], v[184:187], v[56:59]
    v_mfma_f32_16x16x32_bf16 v[60:63], v[160:163], v[188:191], v[60:63]
    v_mfma_f32_16x16x32_bf16 v[64:67], v[160:163], v[192:195], v[64:67]
    v_mfma_f32_16x16x32_bf16 v[68:71], v[160:163], v[196:199], v[68:71]
    ds_write_b128 v249, v[24:27] offset:1024
    ds_write_b128 v249, v[28:31] offset:6144
    ds_write_b128 v249, v[32:35] offset:11264
    ds_write_b128 v249, v[36:39] offset:16384
    v_mfma_f32_16x16x32_bf16 v[72:75], v[164:167], v[184:187], v[72:75]
    v_mfma_f32_16x16x32_bf16 v[76:79], v[164:167], v[188:191], v[76:79]
    v_mfma_f32_16x16x32_bf16 v[80:83], v[164:167], v[192:195], v[80:83]
    v_mfma_f32_16x16x32_bf16 v[84:87], v[164:167], v[196:199], v[84:87]
    ds_write_b128 v249, v[40:43] offset:2048
    ds_write_b128 v249, v[44:47] offset:7168
    ds_write_b128 v249, v[48:51] offset:12288
    ds_write_b128 v249, v[52:55] offset:17408
    ds_write_b128 v249, v[56:59] offset:3072
    ds_write_b128 v249, v[60:63] offset:8192
    ds_write_b128 v249, v[64:67] offset:13312
    ds_write_b128 v249, v[68:71] offset:18432
    ds_write_b128 v249, v[72:75] offset:4096
    ds_write_b128 v249, v[76:79] offset:9216
    ds_write_b128 v249, v[80:83] offset:14336
    ds_write_b128 v249, v[84:87] offset:19456
    s_waitcnt lgkmcnt(0)
    s_barrier
    ds_read_b128 v[88:91], v252 offset:0
    ds_read_b128 v[108:111], v252 offset:20480
    ds_read_b128 v[128:131], v254 offset:0
    ds_read_b128 v[148:151], v254 offset:20480
    ds_read_b64_tr_b16 v[232:233], v253 offset:0
    ds_read_b128 v[92:95], v252 offset:1024
    ds_read_b128 v[112:115], v252 offset:21504
    ds_read_b128 v[132:135], v254 offset:1024
    ds_read_b128 v[152:155], v254 offset:21504
    ds_read_b64_tr_b16 v[234:235], v253 offset:2048
    ds_read_b128 v[96:99], v252 offset:2048
    ds_read_b128 v[116:119], v252 offset:22528
    ds_read_b128 v[136:139], v254 offset:2048
    ds_read_b128 v[156:159], v254 offset:22528
    ds_read_b64_tr_b16 v[236:237], v253 offset:4096
    ds_read_b128 v[100:103], v252 offset:3072
    ds_read_b128 v[120:123], v252 offset:23552
    ds_read_b128 v[140:143], v254 offset:3072
    ds_read_b128 v[160:163], v254 offset:23552
    ds_read_b64_tr_b16 v[238:239], v253 offset:6144
    ds_read_b128 v[104:107], v252 offset:4096
    ds_read_b128 v[124:127], v252 offset:24576
    ds_read_b128 v[144:147], v254 offset:4096
    ds_read_b128 v[164:167], v254 offset:24576
    ds_read_b64_tr_b16 v[240:241], v253 offset:8192
    s_waitcnt vmcnt(0)
    s_waitcnt lgkmcnt(15)
    v_lshlrev_b32 v8, 16, v216
    v_and_b32 v9, 0xffff0000, v216
    v_lshlrev_b32 v10, 16, v217
    v_and_b32 v11, 0xffff0000, v217
    v_lshlrev_b32 v12, 16, v232
    v_and_b32 v13, 0xffff0000, v232
    v_lshlrev_b32 v14, 16, v233
    v_and_b32 v15, 0xffff0000, v233
    v_pk_add_f32 v[88:89], v[88:89], v[108:109]
    v_pk_add_f32 v[128:129], v[128:129], v[148:149]
    v_pk_add_f32 v[8:9], v[8:9], v[12:13]
    v_pk_add_f32 v[88:89], v[88:89], v[128:129]
    v_pk_add_f32 v[8:9], v[8:9], v[88:89]
    v_pk_add_f32 v[90:91], v[90:91], v[110:111]
    v_pk_add_f32 v[130:131], v[130:131], v[150:151]
    v_pk_add_f32 v[10:11], v[10:11], v[14:15]
    v_pk_add_f32 v[90:91], v[90:91], v[130:131]
    v_pk_add_f32 v[10:11], v[10:11], v[90:91]
    v_cvt_pk_bf16_f32 v16, v8, v9
    v_cvt_pk_bf16_f32 v17, v10, v11
    buffer_store_dwordx2 v[16:17], v248, s[52:55], s68 offen offset:0
    s_waitcnt lgkmcnt(15)
    v_lshlrev_b32 v20, 16, v218
    v_and_b32 v21, 0xffff0000, v218
    v_lshlrev_b32 v22, 16, v219
    v_and_b32 v23, 0xffff0000, v219
    v_lshlrev_b32 v24, 16, v234
    v_and_b32 v25, 0xffff0000, v234
    v_lshlrev_b32 v26, 16, v235
    v_and_b32 v27, 0xffff0000, v235
    v_pk_add_f32 v[92:93], v[92:93], v[112:113]
    v_pk_add_f32 v[132:133], v[132:133], v[152:153]
    v_pk_add_f32 v[20:21], v[20:21], v[24:25]
    v_pk_add_f32 v[92:93], v[92:93], v[132:133]
    v_pk_add_f32 v[20:21], v[20:21], v[92:93]
    v_pk_add_f32 v[94:95], v[94:95], v[114:115]
    v_pk_add_f32 v[134:135], v[134:135], v[154:155]
    v_pk_add_f32 v[22:23], v[22:23], v[26:27]
    v_pk_add_f32 v[94:95], v[94:95], v[134:135]
    v_pk_add_f32 v[22:23], v[22:23], v[94:95]
    v_cvt_pk_bf16_f32 v28, v20, v21
    v_cvt_pk_bf16_f32 v29, v22, v23
    buffer_store_dwordx2 v[28:29], v248, s[52:55], s68 offen offset:32
    s_waitcnt lgkmcnt(10)
    v_lshlrev_b32 v8, 16, v220
    v_and_b32 v9, 0xffff0000, v220
    v_lshlrev_b32 v10, 16, v221
    v_and_b32 v11, 0xffff0000, v221
    v_lshlrev_b32 v12, 16, v236
    v_and_b32 v13, 0xffff0000, v236
    v_lshlrev_b32 v14, 16, v237
    v_and_b32 v15, 0xffff0000, v237
    v_pk_add_f32 v[96:97], v[96:97], v[116:117]
    v_pk_add_f32 v[136:137], v[136:137], v[156:157]
    v_pk_add_f32 v[8:9], v[8:9], v[12:13]
    v_pk_add_f32 v[96:97], v[96:97], v[136:137]
    v_pk_add_f32 v[8:9], v[8:9], v[96:97]
    v_pk_add_f32 v[98:99], v[98:99], v[118:119]
    v_pk_add_f32 v[138:139], v[138:139], v[158:159]
    v_pk_add_f32 v[10:11], v[10:11], v[14:15]
    v_pk_add_f32 v[98:99], v[98:99], v[138:139]
    v_pk_add_f32 v[10:11], v[10:11], v[98:99]
    v_cvt_pk_bf16_f32 v16, v8, v9
    v_cvt_pk_bf16_f32 v17, v10, v11
    buffer_store_dwordx2 v[16:17], v248, s[52:55], s68 offen offset:64
    s_waitcnt lgkmcnt(5)
    v_lshlrev_b32 v20, 16, v222
    v_and_b32 v21, 0xffff0000, v222
    v_lshlrev_b32 v22, 16, v223
    v_and_b32 v23, 0xffff0000, v223
    v_lshlrev_b32 v24, 16, v238
    v_and_b32 v25, 0xffff0000, v238
    v_lshlrev_b32 v26, 16, v239
    v_and_b32 v27, 0xffff0000, v239
    v_pk_add_f32 v[100:101], v[100:101], v[120:121]
    v_pk_add_f32 v[140:141], v[140:141], v[160:161]
    v_pk_add_f32 v[20:21], v[20:21], v[24:25]
    v_pk_add_f32 v[100:101], v[100:101], v[140:141]
    v_pk_add_f32 v[20:21], v[20:21], v[100:101]
    v_pk_add_f32 v[102:103], v[102:103], v[122:123]
    v_pk_add_f32 v[142:143], v[142:143], v[162:163]
    v_pk_add_f32 v[22:23], v[22:23], v[26:27]
    v_pk_add_f32 v[102:103], v[102:103], v[142:143]
    v_pk_add_f32 v[22:23], v[22:23], v[102:103]
    v_cvt_pk_bf16_f32 v28, v20, v21
    v_cvt_pk_bf16_f32 v29, v22, v23
    buffer_store_dwordx2 v[28:29], v248, s[52:55], s68 offen offset:96
    s_waitcnt lgkmcnt(0)
    v_lshlrev_b32 v8, 16, v224
    v_and_b32 v9, 0xffff0000, v224
    v_lshlrev_b32 v10, 16, v225
    v_and_b32 v11, 0xffff0000, v225
    v_lshlrev_b32 v12, 16, v240
    v_and_b32 v13, 0xffff0000, v240
    v_lshlrev_b32 v14, 16, v241
    v_and_b32 v15, 0xffff0000, v241
    v_pk_add_f32 v[104:105], v[104:105], v[124:125]
    v_pk_add_f32 v[144:145], v[144:145], v[164:165]
    v_pk_add_f32 v[8:9], v[8:9], v[12:13]
    v_pk_add_f32 v[104:105], v[104:105], v[144:145]
    v_pk_add_f32 v[8:9], v[8:9], v[104:105]
    v_pk_add_f32 v[106:107], v[106:107], v[126:127]
    v_pk_add_f32 v[146:147], v[146:147], v[166:167]
    v_pk_add_f32 v[10:11], v[10:11], v[14:15]
    v_pk_add_f32 v[106:107], v[106:107], v[146:147]
    v_pk_add_f32 v[10:11], v[10:11], v[106:107]
    v_cvt_pk_bf16_f32 v16, v8, v9
    v_cvt_pk_bf16_f32 v17, v10, v11
    buffer_store_dwordx2 v[16:17], v248, s[52:55], s68 offen offset:128
    s_branch L_fin_39
L_loader_4:
    s_sub_u32 s60, s40, 4
    s_lshl_b32 s56, s42, 4
    s_mul_i32 s57, s43, 3
    s_lshr_b32 s57, s57, 1
    s_mul_i32 s57, s57, 10
    s_sub_u32 s57, s57, 16
    v_add_u32 v3, s56, v1
    v_add_u32 v4, s57, v1
    v_cmp_gt_u32 vcc, 16, v1
    s_nop 1
    v_cndmask_b32 v3, v4, v3, vcc
    v_mov_b32 v4, s56
    v_cmp_gt_u32 vcc, 36, v1
    s_nop 1
    v_cndmask_b32 v3, v4, v3, vcc
    v_lshlrev_b32 v3, 7, v3
    s_mov_b32 s61, 20054016
    v_lshlrev_b32 v2, 4, v1
    s_mul_i32 s56, s60, 5
    s_add_u32 s56, s56, 0
    s_lshl_b32 s64, s56, 10
    s_cmp_ge_u32 s56, 8
    s_cbranch_scc1 L_px_40
    s_lshr_b32 s57, s56, 1
    s_lshl_b32 s58, s42, 2
    s_add_u32 s57, s57, s58
    s_mul_i32 s57, s57, 40960
    s_and_b32 s58, s56, 1
    s_lshl_b32 s58, s58, 10
    s_add_u32 s57, s57, s58
    s_add_u32 s48, s57, 0
    s_mov_b32 s53, 2048
    s_branch L_pd_41
L_px_40:
    s_sub_u32 s57, s56, 8
    s_lshl_b32 s57, s57, 10
    s_mul_i32 s58, s43, 245760
    s_add_u32 s57, s57, s58
    s_add_u32 s48, s57, 5242880
    s_mov_b32 s53, 12288
L_pd_41:
    s_mul_i32 s56, s60, 5
    s_add_u32 s56, s56, 1
    s_lshl_b32 s65, s56, 10
    s_cmp_ge_u32 s56, 8
    s_cbranch_scc1 L_px_42
    s_lshr_b32 s57, s56, 1
    s_lshl_b32 s58, s42, 2
    s_add_u32 s57, s57, s58
    s_mul_i32 s57, s57, 40960
    s_and_b32 s58, s56, 1
    s_lshl_b32 s58, s58, 10
    s_add_u32 s57, s57, s58
    s_add_u32 s49, s57, 0
    s_mov_b32 s54, 2048
    s_branch L_pd_43
L_px_42:
    s_sub_u32 s57, s56, 8
    s_lshl_b32 s57, s57, 10
    s_mul_i32 s58, s43, 245760
    s_add_u32 s57, s57, s58
    s_add_u32 s49, s57, 5242880
    s_mov_b32 s54, 12288
L_pd_43:
    s_mul_i32 s56, s60, 5
    s_add_u32 s56, s56, 2
    s_lshl_b32 s66, s56, 10
    s_cmp_ge_u32 s56, 8
    s_cbranch_scc1 L_px_44
    s_lshr_b32 s57, s56, 1
    s_lshl_b32 s58, s42, 2
    s_add_u32 s57, s57, s58
    s_mul_i32 s57, s57, 40960
    s_and_b32 s58, s56, 1
    s_lshl_b32 s58, s58, 10
    s_add_u32 s57, s57, s58
    s_add_u32 s50, s57, 0
    s_mov_b32 s55, 2048
    s_branch L_pd_45
L_px_44:
    s_sub_u32 s57, s56, 8
    s_lshl_b32 s57, s57, 10
    s_mul_i32 s58, s43, 245760
    s_add_u32 s57, s57, s58
    s_add_u32 s50, s57, 5242880
    s_mov_b32 s55, 12288
L_pd_45:
    s_mul_i32 s56, s60, 5
    s_add_u32 s56, s56, 3
    s_lshl_b32 s67, s56, 10
    s_cmp_ge_u32 s56, 8
    s_cbranch_scc1 L_px_46
    s_lshr_b32 s57, s56, 1
    s_lshl_b32 s58, s42, 2
    s_add_u32 s57, s57, s58
    s_mul_i32 s57, s57, 40960
    s_and_b32 s58, s56, 1
    s_lshl_b32 s58, s58, 10
    s_add_u32 s57, s57, s58
    s_add_u32 s51, s57, 0
    s_mov_b32 s62, 2048
    s_branch L_pd_47
L_px_46:
    s_sub_u32 s57, s56, 8
    s_lshl_b32 s57, s57, 10
    s_mul_i32 s58, s43, 245760
    s_add_u32 s57, s57, s58
    s_add_u32 s51, s57, 5242880
    s_mov_b32 s62, 12288
L_pd_47:
    s_mul_i32 s56, s60, 5
    s_add_u32 s56, s56, 4
    s_lshl_b32 s68, s56, 10
    s_cmp_ge_u32 s56, 8
    s_cbranch_scc1 L_px_48
    s_lshr_b32 s57, s56, 1
    s_lshl_b32 s58, s42, 2
    s_add_u32 s57, s57, s58
    s_mul_i32 s57, s57, 40960
    s_and_b32 s58, s56, 1
    s_lshl_b32 s58, s58, 10
    s_add_u32 s57, s57, s58
    s_add_u32 s52, s57, 0
    s_mov_b32 s63, 2048
    s_branch L_pd_49
L_px_48:
    s_sub_u32 s57, s56, 8
    s_lshl_b32 s57, s57, 10
    s_mul_i32 s58, s43, 245760
    s_add_u32 s57, s57, s58
    s_add_u32 s52, s57, 5242880
    s_mov_b32 s63, 12288
L_pd_49:
    s_mov_b32 s57, 0
L_poll_50:
    buffer_load_dword v4, v3, s[36:39], s61 offen sc1
    s_waitcnt vmcnt(0)
    v_xor_b32 v4, s41, v4
    v_cmp_ne_u32 vcc, 0, v4
    s_add_u32 s57, s57, 1
    s_cmp_gt_u32 s57, 65536
    s_cbranch_scc1 L_polld_51
    s_cmp_eq_u64 vcc, 0
    s_cbranch_scc0 L_poll_50
L_polld_51:
    s_cmp_eq_u32 s40, 7
    s_cbranch_scc1 L_sync_52
    s_mov_b32 s69, 0
    s_add_u32 m0, s69, s64
    s_nop 0
    buffer_load_dwordx4 v2, s[36:39], s48 offen sc1 lds
    s_add_u32 s48, s48, s53
    s_add_u32 m0, s69, s65
    s_nop 0
    buffer_load_dwordx4 v2, s[36:39], s49 offen sc1 lds
    s_add_u32 s49, s49, s54
    s_add_u32 m0, s69, s66
    s_nop 0
    buffer_load_dwordx4 v2, s[36:39], s50 offen sc1 lds
    s_add_u32 s50, s50, s55
    s_add_u32 m0, s69, s67
    s_nop 0
    buffer_load_dwordx4 v2, s[36:39], s51 offen sc1 lds
    s_add_u32 s51, s51, s62
    s_add_u32 m0, s69, s68
    s_nop 0
    buffer_load_dwordx4 v2, s[36:39], s52 offen sc1 lds
    s_add_u32 s52, s52, s63
    s_add_u32 s69, s69, 20480
    s_cmp_eq_u32 s69, 102400
    s_cselect_b32 s69, 0, s69
    s_add_u32 m0, s69, s64
    s_nop 0
    buffer_load_dwordx4 v2, s[36:39], s48 offen sc1 lds
    s_add_u32 s48, s48, s53
    s_add_u32 m0, s69, s65
    s_nop 0
    buffer_load_dwordx4 v2, s[36:39], s49 offen sc1 lds
    s_add_u32 s49, s49, s54
    s_add_u32 m0, s69, s66
    s_nop 0
    buffer_load_dwordx4 v2, s[36:39], s50 offen sc1 lds
    s_add_u32 s50, s50, s55
    s_add_u32 m0, s69, s67
    s_nop 0
    buffer_load_dwordx4 v2, s[36:39], s51 offen sc1 lds
    s_add_u32 s51, s51, s62
    s_add_u32 m0, s69, s68
    s_nop 0
    buffer_load_dwordx4 v2, s[36:39], s52 offen sc1 lds
    s_add_u32 s52, s52, s63
    s_add_u32 s69, s69, 20480
    s_cmp_eq_u32 s69, 102400
    s_cselect_b32 s69, 0, s69
    s_add_u32 m0, s69, s64
    s_nop 0
    buffer_load_dwordx4 v2, s[36:39], s48 offen sc1 lds
    s_add_u32 s48, s48, s53
    s_add_u32 m0, s69, s65
    s_nop 0
    buffer_load_dwordx4 v2, s[36:39], s49 offen sc1 lds
    s_add_u32 s49, s49, s54
    s_add_u32 m0, s69, s66
    s_nop 0
    buffer_load_dwordx4 v2, s[36:39], s50 offen sc1 lds
    s_add_u32 s50, s50, s55
    s_add_u32 m0, s69, s67
    s_nop 0
    buffer_load_dwordx4 v2, s[36:39], s51 offen sc1 lds
    s_add_u32 s51, s51, s62
    s_add_u32 m0, s69, s68
    s_nop 0
    buffer_load_dwordx4 v2, s[36:39], s52 offen sc1 lds
    s_add_u32 s52, s52, s63
    s_add_u32 s69, s69, 20480
    s_cmp_eq_u32 s69, 102400
    s_cselect_b32 s69, 0, s69
    s_barrier
    s_waitcnt vmcnt(5)
    s_barrier
    s_add_u32 m0, s69, s64
    s_nop 0
    buffer_load_dwordx4 v2, s[36:39], s48 offen sc1 lds
    s_add_u32 s48, s48, s53
    s_add_u32 m0, s69, s65
    s_nop 0
    buffer_load_dwordx4 v2, s[36:39], s49 offen sc1 lds
    s_add_u32 s49, s49, s54
    s_add_u32 m0, s69, s66
    s_nop 0
    buffer_load_dwordx4 v2, s[36:39], s50 offen sc1 lds
    s_add_u32 s50, s50, s55
    s_add_u32 m0, s69, s67
    s_nop 0
    buffer_load_dwordx4 v2, s[36:39], s51 offen sc1 lds
    s_add_u32 s51, s51, s62
    s_add_u32 m0, s69, s68
    s_nop 0
    buffer_load_dwordx4 v2, s[36:39], s52 offen sc1 lds
    s_add_u32 s52, s52, s63
    s_add_u32 s69, s69, 20480
    s_cmp_eq_u32 s69, 102400
    s_cselect_b32 s69, 0, s69
    s_add_u32 m0, s69, s64
    s_nop 0
    buffer_load_dwordx4 v2, s[36:39], s48 offen sc1 lds
    s_add_u32 s48, s48, s53
    s_add_u32 m0, s69, s65
    s_nop 0
    buffer_load_dwordx4 v2, s[36:39], s49 offen sc1 lds
    s_add_u32 s49, s49, s54
    s_add_u32 m0, s69, s66
    s_nop 0
    buffer_load_dwordx4 v2, s[36:39], s50 offen sc1 lds
    s_add_u32 s50, s50, s55
    s_add_u32 m0, s69, s67
    s_nop 0
    buffer_load_dwordx4 v2, s[36:39], s51 offen sc1 lds
    s_add_u32 s51, s51, s62
    s_add_u32 m0, s69, s68
    s_nop 0
    buffer_load_dwordx4 v2, s[36:39], s52 offen sc1 lds
    s_add_u32 s52, s52, s63
    s_add_u32 s69, s69, 20480
    s_cmp_eq_u32 s69, 102400
    s_cselect_b32 s69, 0, s69
    s_waitcnt vmcnt(10)
    s_barrier
    s_mov_b32 s61, 15
L_steady_53:
    s_add_u32 m0, s69, s64
    s_nop 0
    buffer_load_dwordx4 v2, s[36:39], s48 offen sc1 lds
    s_add_u32 s48, s48, s53
    s_add_u32 m0, s69, s65
    s_nop 0
    buffer_load_dwordx4 v2, s[36:39], s49 offen sc1 lds
    s_add_u32 s49, s49, s54
    s_add_u32 m0, s69, s66
    s_nop 0
    buffer_load_dwordx4 v2, s[36:39], s50 offen sc1 lds
    s_add_u32 s50, s50, s55
    s_add_u32 m0, s69, s67
    s_nop 0
    buffer_load_dwordx4 v2, s[36:39], s51 offen sc1 lds
    s_add_u32 s51, s51, s62
    s_add_u32 m0, s69, s68
    s_nop 0
    buffer_load_dwordx4 v2, s[36:39], s52 offen sc1 lds
    s_add_u32 s52, s52, s63
    s_add_u32 s69, s69, 20480
    s_cmp_eq_u32 s69, 102400
    s_cselect_b32 s69, 0, s69
    s_waitcnt vmcnt(10)
    s_barrier
    s_sub_u32 s61, s61, 1
    s_cmp_lg_u32 s61, 0
    s_cbranch_scc1 L_steady_53
    s_cmp_ge_u32 s60, s47
    s_cbranch_scc1 L_nou_54
    v_mov_b32 v4, 163724
    s_mov_b32 s57, 0
L_lw_55:
    ds_read_b32 v5, v4
    s_waitcnt lgkmcnt(0)
    v_readfirstlane_b32 s56, v5
    s_nop 0
    s_cmp_eq_u32 s56, 1
    s_cbranch_scc1 L_lwd_56
    s_add_u32 s57, s57, 1
    s_cmp_gt_u32 s57, 262144
    s_cbranch_scc1 L_lwd_56
    s_sleep 1
    s_branch L_lw_55
L_lwd_56:
    s_mul_i32 s64, s60, 4608
    s_lshl_b32 s62, s60, 5
    s_add_u32 s62, s62, s46
    v_mul_u32_u24 v3, 10240, v1
    s_lshl_b32 s66, s62, 4
    s_add_u32 s66, s66, 2621440
    s_add_u32 m0, s64, 512
    s_add_u32 s67, s66, 0
    buffer_load_dwordx4 v3, s[36:39], s67 offen sc1 lds
    s_add_u32 m0, s64, 1536
    s_add_u32 s67, s66, 655360
    buffer_load_dwordx4 v3, s[36:39], s67 offen sc1 lds
    s_add_u32 m0, s64, 2560
    s_add_u32 s67, s66, 1310720
    buffer_load_dwordx4 v3, s[36:39], s67 offen sc1 lds
    s_add_u32 m0, s64, 3584
    s_add_u32 s67, s66, 1966080
    buffer_load_dwordx4 v3, s[36:39], s67 offen sc1 lds
    v_mov_b32 v4, 0
    v_mov_b32 v5, 0
    v_mov_b32 v6, 0
    v_mov_b32 v7, 0
    v_add_u32 v8, s64, v2
    s_mov_b64 s[58:59], exec
    s_mov_b32 exec_hi, 0
    ds_write_b128 v8, v[4:7]
    s_mov_b64 exec, s[58:59]
    s_waitcnt vmcnt(9)
    s_barrier
    s_waitcnt vmcnt(4)
    s_barrier
    s_waitcnt vmcnt(4)
    s_barrier
    s_branch L_join_57
L_nou_54:
    s_waitcnt vmcnt(5)
    s_barrier
    s_waitcnt vmcnt(0)
    s_barrier
    s_waitcnt vmcnt(0)
    s_barrier
L_join_57:
    s_barrier
    s_cmp_ge_u32 s60, s47
    s_cbranch_scc1 L_fin_39
    v_and_b32 v10, 15, v1
    v_lshrrev_b32 v11, 4, v1
    v_add_u32 v12, 1, v10
    v_and_b32 v12, 3, v12
    v_mul_u32_u24 v13, 4160, v12
    v_lshrrev_b32 v15, 1, v11
    v_lshl_add_u32 v14, v15, 4, v10
    v_and_b32 v15, 1, v11
    v_lshlrev_b32 v15, 3, v15
    v_sub_u32 v14, v14, v15
    v_add_u32 v14, 9, v14
    v_sub_u32 v14, v14, v12
    v_lshl_add_u32 v224, v14, 1, v13
    v_lshlrev_b32 v13, 5, v10
    v_lshrrev_b32 v15, 1, v11
    v_lshlrev_b32 v15, 5, v15
    v_sub_u32 v13, v13, v15
    v_and_b32 v15, 1, v11
    v_lshl_add_u32 v13, v15, 4, v13
    v_add_u32 v225, 512, v13
    s_mul_i32 s65, s60, 16640
    s_add_u32 s65, s65, 102400
    v_add_u32 v2, s65, v224
    v_add_u32 v3, s64, v225
    v_mov_b32 v64, 0
    v_mov_b32 v65, 0
    v_mov_b32 v66, 0
    v_mov_b32 v67, 0
    v_mov_b32 v68, 0
    v_mov_b32 v69, 0
    v_mov_b32 v70, 0
    v_mov_b32 v71, 0
    v_mov_b32 v72, 0
    v_mov_b32 v73, 0
    v_mov_b32 v74, 0
    v_mov_b32 v75, 0
    v_mov_b32 v76, 0
    v_mov_b32 v77, 0
    v_mov_b32 v78, 0
    v_mov_b32 v79, 0
    v_mov_b32 v80, 0
    v_mov_b32 v81, 0
    v_mov_b32 v82, 0
    v_mov_b32 v83, 0
    v_mov_b32 v84, 0
    v_mov_b32 v85, 0
    v_mov_b32 v86, 0
    v_mov_b32 v87, 0
    v_mov_b32 v88, 0
    v_mov_b32 v89, 0
    v_mov_b32 v90, 0
    v_mov_b32 v91, 0
    v_mov_b32 v92, 0
    v_mov_b32 v93, 0
    v_mov_b32 v94, 0
    v_mov_b32 v95, 0
    v_lshlrev_b32 v9, 16, v216
    s_waitcnt vmcnt(0) lgkmcnt(0)
    s_mov_b32 s66, 0
L_cmain_58:
    ds_read_b128 v[96:99], v3 offset:0
    ds_read_b64 v[160:161], v2 offset:0
    ds_read_b64 v[162:163], v2 offset:8
    ds_read_b128 v[100:103], v3 offset:512
    ds_read_b64 v[164:165], v2 offset:512
    ds_read_b64 v[166:167], v2 offset:520
    ds_read_b128 v[104:107], v3 offset:1024
    ds_read_b64 v[168:169], v2 offset:1024
    ds_read_b64 v[170:171], v2 offset:1032
    ds_read_b128 v[108:111], v3 offset:1536
    ds_read_b64 v[172:173], v2 offset:1536
    ds_read_b64 v[174:175], v2 offset:1544
    ds_read_b128 v[112:115], v3 offset:2048
    ds_read_b64 v[176:177], v2 offset:2048
    ds_read_b64 v[178:179], v2 offset:2056
    ds_read_b128 v[116:119], v3 offset:2560
    ds_read_b64 v[180:181], v2 offset:2560
    ds_read_b64 v[182:183], v2 offset:2568
    ds_read_b128 v[120:123], v3 offset:3072
    ds_read_b64 v[184:185], v2 offset:3072
    ds_read_b64 v[186:187], v2 offset:3080
    ds_read_b128 v[124:127], v3 offset:3584
    ds_read_b64 v[188:189], v2 offset:3584
    ds_read_b64 v[190:191], v2 offset:3592
    s_waitcnt lgkmcnt(0)
L_p0_60:
    v_add_u32 v2, 64, v2
    v_subrev_u32 v3, 64, v3
    v_mfma_f32_16x16x32_bf16 v[64:67], v[160:163], v[96:99], v[64:67]
    ds_read_b128 v[128:131], v3 offset:0
    v_mfma_f32_16x16x32_bf16 v[68:71], v[160:163], v[100:103], v[68:71]
    ds_read_b64 v[192:193], v2 offset:0
    v_mfma_f32_16x16x32_bf16 v[72:75], v[160:163], v[104:107], v[72:75]
    v_mfma_f32_16x16x32_bf16 v[76:79], v[160:163], v[108:111], v[76:79]
    ds_read_b64 v[194:195], v2 offset:8
    v_mfma_f32_16x16x32_bf16 v[80:83], v[160:163], v[112:115], v[80:83]
    ds_read_b128 v[132:135], v3 offset:512
    v_mfma_f32_16x16x32_bf16 v[84:87], v[160:163], v[116:119], v[84:87]
    v_mfma_f32_16x16x32_bf16 v[88:91], v[160:163], v[120:123], v[88:91]
    ds_read_b64 v[196:197], v2 offset:512
    v_mfma_f32_16x16x32_bf16 v[92:95], v[160:163], v[124:127], v[92:95]
    ds_read_b64 v[198:199], v2 offset:520
    v_mfma_f32_16x16x32_bf16 v[68:71], v[164:167], v[96:99], v[68:71]
    v_mfma_f32_16x16x32_bf16 v[72:75], v[164:167], v[100:103], v[72:75]
    ds_read_b128 v[136:139], v3 offset:1024
    v_mfma_f32_16x16x32_bf16 v[76:79], v[164:167], v[104:107], v[76:79]
    ds_read_b64 v[200:201], v2 offset:1024
    v_mfma_f32_16x16x32_bf16 v[80:83], v[164:167], v[108:111], v[80:83]
    v_mfma_f32_16x16x32_bf16 v[84:87], v[164:167], v[112:115], v[84:87]
    ds_read_b64 v[202:203], v2 offset:1032
    v_mfma_f32_16x16x32_bf16 v[88:91], v[164:167], v[116:119], v[88:91]
    ds_read_b128 v[140:143], v3 offset:1536
    v_mfma_f32_16x16x32_bf16 v[92:95], v[164:167], v[120:123], v[92:95]
    v_mfma_f32_16x16x32_bf16 v[72:75], v[168:171], v[96:99], v[72:75]
    ds_read_b64 v[204:205], v2 offset:1536
    v_mfma_f32_16x16x32_bf16 v[76:79], v[168:171], v[100:103], v[76:79]
    ds_read_b64 v[206:207], v2 offset:1544
    v_mfma_f32_16x16x32_bf16 v[80:83], v[168:171], v[104:107], v[80:83]
    v_mfma_f32_16x16x32_bf16 v[84:87], v[168:171], v[108:111], v[84:87]
    ds_read_b128 v[144:147], v3 offset:2048
    v_mfma_f32_16x16x32_bf16 v[88:91], v[168:171], v[112:115], v[88:91]
    ds_read_b64 v[208:209], v2 offset:2048
    v_mfma_f32_16x16x32_bf16 v[92:95], v[168:171], v[116:119], v[92:95]
    v_mfma_f32_16x16x32_bf16 v[76:79], v[172:175], v[96:99], v[76:79]
    ds_read_b64 v[210:211], v2 offset:2056
    v_mfma_f32_16x16x32_bf16 v[80:83], v[172:175], v[100:103], v[80:83]
    ds_read_b128 v[148:151], v3 offset:2560
    v_mfma_f32_16x16x32_bf16 v[84:87], v[172:175], v[104:107], v[84:87]
    v_mfma_f32_16x16x32_bf16 v[88:91], v[172:175], v[108:111], v[88:91]
    ds_read_b64 v[212:213], v2 offset:2560
    v_mfma_f32_16x16x32_bf16 v[92:95], v[172:175], v[112:115], v[92:95]
    ds_read_b64 v[214:215], v2 offset:2568
    v_mfma_f32_16x16x32_bf16 v[80:83], v[176:179], v[96:99], v[80:83]
    v_mfma_f32_16x16x32_bf16 v[84:87], v[176:179], v[100:103], v[84:87]
    ds_read_b128 v[152:155], v3 offset:3072
    v_mfma_f32_16x16x32_bf16 v[88:91], v[176:179], v[104:107], v[88:91]
    ds_read_b64 v[216:217], v2 offset:3072
    v_mfma_f32_16x16x32_bf16 v[92:95], v[176:179], v[108:111], v[92:95]
    v_mfma_f32_16x16x32_bf16 v[84:87], v[180:183], v[96:99], v[84:87]
    ds_read_b64 v[218:219], v2 offset:3080
    v_mfma_f32_16x16x32_bf16 v[88:91], v[180:183], v[100:103], v[88:91]
    ds_read_b128 v[156:159], v3 offset:3584
    v_mfma_f32_16x16x32_bf16 v[92:95], v[180:183], v[104:107], v[92:95]
    v_mfma_f32_16x16x32_bf16 v[88:91], v[184:187], v[96:99], v[88:91]
    ds_read_b64 v[220:221], v2 offset:3584
    v_mfma_f32_16x16x32_bf16 v[92:95], v[184:187], v[100:103], v[92:95]
    ds_read_b64 v[222:223], v2 offset:3592
    v_mfma_f32_16x16x32_bf16 v[92:95], v[188:191], v[96:99], v[92:95]
    s_waitcnt lgkmcnt(0)
    s_cmp_eq_u32 s66, 3
    s_cbranch_scc1 L_p0e_61
    v_add_u32 v2, 64, v2
    v_subrev_u32 v3, 64, v3
    v_mfma_f32_16x16x32_bf16 v[64:67], v[192:195], v[128:131], v[64:67]
    ds_read_b128 v[96:99], v3 offset:0
    v_mfma_f32_16x16x32_bf16 v[68:71], v[192:195], v[132:135], v[68:71]
    ds_read_b64 v[160:161], v2 offset:0
    v_mfma_f32_16x16x32_bf16 v[72:75], v[192:195], v[136:139], v[72:75]
    v_mfma_f32_16x16x32_bf16 v[76:79], v[192:195], v[140:143], v[76:79]
    ds_read_b64 v[162:163], v2 offset:8
    v_mfma_f32_16x16x32_bf16 v[80:83], v[192:195], v[144:147], v[80:83]
    ds_read_b128 v[100:103], v3 offset:512
    v_mfma_f32_16x16x32_bf16 v[84:87], v[192:195], v[148:151], v[84:87]
    v_mfma_f32_16x16x32_bf16 v[88:91], v[192:195], v[152:155], v[88:91]
    ds_read_b64 v[164:165], v2 offset:512
    v_mfma_f32_16x16x32_bf16 v[92:95], v[192:195], v[156:159], v[92:95]
    ds_read_b64 v[166:167], v2 offset:520
    v_mfma_f32_16x16x32_bf16 v[68:71], v[196:199], v[128:131], v[68:71]
    v_mfma_f32_16x16x32_bf16 v[72:75], v[196:199], v[132:135], v[72:75]
    ds_read_b128 v[104:107], v3 offset:1024
    v_mfma_f32_16x16x32_bf16 v[76:79], v[196:199], v[136:139], v[76:79]
    ds_read_b64 v[168:169], v2 offset:1024
    v_mfma_f32_16x16x32_bf16 v[80:83], v[196:199], v[140:143], v[80:83]
    v_mfma_f32_16x16x32_bf16 v[84:87], v[196:199], v[144:147], v[84:87]
    ds_read_b64 v[170:171], v2 offset:1032
    v_mfma_f32_16x16x32_bf16 v[88:91], v[196:199], v[148:151], v[88:91]
    ds_read_b128 v[108:111], v3 offset:1536
    v_mfma_f32_16x16x32_bf16 v[92:95], v[196:199], v[152:155], v[92:95]
    v_mfma_f32_16x16x32_bf16 v[72:75], v[200:203], v[128:131], v[72:75]
    ds_read_b64 v[172:173], v2 offset:1536
    v_mfma_f32_16x16x32_bf16 v[76:79], v[200:203], v[132:135], v[76:79]
    ds_read_b64 v[174:175], v2 offset:1544
    v_mfma_f32_16x16x32_bf16 v[80:83], v[200:203], v[136:139], v[80:83]
    v_mfma_f32_16x16x32_bf16 v[84:87], v[200:203], v[140:143], v[84:87]
    ds_read_b128 v[112:115], v3 offset:2048
    v_mfma_f32_16x16x32_bf16 v[88:91], v[200:203], v[144:147], v[88:91]
    ds_read_b64 v[176:177], v2 offset:2048
    v_mfma_f32_16x16x32_bf16 v[92:95], v[200:203], v[148:151], v[92:95]
    v_mfma_f32_16x16x32_bf16 v[76:79], v[204:207], v[128:131], v[76:79]
    ds_read_b64 v[178:179], v2 offset:2056
    v_mfma_f32_16x16x32_bf16 v[80:83], v[204:207], v[132:135], v[80:83]
    ds_read_b128 v[116:119], v3 offset:2560
    v_mfma_f32_16x16x32_bf16 v[84:87], v[204:207], v[136:139], v[84:87]
    v_mfma_f32_16x16x32_bf16 v[88:91], v[204:207], v[140:143], v[88:91]
    ds_read_b64 v[180:181], v2 offset:2560
    v_mfma_f32_16x16x32_bf16 v[92:95], v[204:207], v[144:147], v[92:95]
    ds_read_b64 v[182:183], v2 offset:2568
    v_mfma_f32_16x16x32_bf16 v[80:83], v[208:211], v[128:131], v[80:83]
    v_mfma_f32_16x16x32_bf16 v[84:87], v[208:211], v[132:135], v[84:87]
    ds_read_b128 v[120:123], v3 offset:3072
    v_mfma_f32_16x16x32_bf16 v[88:91], v[208:211], v[136:139], v[88:91]
    ds_read_b64 v[184:185], v2 offset:3072
    v_mfma_f32_16x16x32_bf16 v[92:95], v[208:211], v[140:143], v[92:95]
    v_mfma_f32_16x16x32_bf16 v[84:87], v[212:215], v[128:131], v[84:87]
    ds_read_b64 v[186:187], v2 offset:3080
    v_mfma_f32_16x16x32_bf16 v[88:91], v[212:215], v[132:135], v[88:91]
    ds_read_b128 v[124:127], v3 offset:3584
    v_mfma_f32_16x16x32_bf16 v[92:95], v[212:215], v[136:139], v[92:95]
    v_mfma_f32_16x16x32_bf16 v[88:91], v[216:219], v[128:131], v[88:91]
    ds_read_b64 v[188:189], v2 offset:3584
    v_mfma_f32_16x16x32_bf16 v[92:95], v[216:219], v[132:135], v[92:95]
    ds_read_b64 v[190:191], v2 offset:3592
    v_mfma_f32_16x16x32_bf16 v[92:95], v[220:223], v[128:131], v[92:95]
    s_waitcnt lgkmcnt(0)
    s_add_u32 s66, s66, 1
    s_branch L_p0_60
L_p0e_61:
    v_mfma_f32_16x16x32_bf16 v[64:67], v[192:195], v[128:131], v[64:67]
    v_mfma_f32_16x16x32_bf16 v[68:71], v[192:195], v[132:135], v[68:71]
    v_mfma_f32_16x16x32_bf16 v[72:75], v[192:195], v[136:139], v[72:75]
    v_mfma_f32_16x16x32_bf16 v[76:79], v[192:195], v[140:143], v[76:79]
    v_mfma_f32_16x16x32_bf16 v[80:83], v[192:195], v[144:147], v[80:83]
    v_mfma_f32_16x16x32_bf16 v[84:87], v[192:195], v[148:151], v[84:87]
    v_mfma_f32_16x16x32_bf16 v[88:91], v[192:195], v[152:155], v[88:91]
    v_mfma_f32_16x16x32_bf16 v[92:95], v[192:195], v[156:159], v[92:95]
    v_mfma_f32_16x16x32_bf16 v[68:71], v[196:199], v[128:131], v[68:71]
    v_mfma_f32_16x16x32_bf16 v[72:75], v[196:199], v[132:135], v[72:75]
    v_mfma_f32_16x16x32_bf16 v[76:79], v[196:199], v[136:139], v[76:79]
    v_mfma_f32_16x16x32_bf16 v[80:83], v[196:199], v[140:143], v[80:83]
    v_mfma_f32_16x16x32_bf16 v[84:87], v[196:199], v[144:147], v[84:87]
    v_mfma_f32_16x16x32_bf16 v[88:91], v[196:199], v[148:151], v[88:91]
    v_mfma_f32_16x16x32_bf16 v[92:95], v[196:199], v[152:155], v[92:95]
    v_mfma_f32_16x16x32_bf16 v[72:75], v[200:203], v[128:131], v[72:75]
    v_mfma_f32_16x16x32_bf16 v[76:79], v[200:203], v[132:135], v[76:79]
    v_mfma_f32_16x16x32_bf16 v[80:83], v[200:203], v[136:139], v[80:83]
    v_mfma_f32_16x16x32_bf16 v[84:87], v[200:203], v[140:143], v[84:87]
    v_mfma_f32_16x16x32_bf16 v[88:91], v[200:203], v[144:147], v[88:91]
    v_mfma_f32_16x16x32_bf16 v[92:95], v[200:203], v[148:151], v[92:95]
    v_mfma_f32_16x16x32_bf16 v[76:79], v[204:207], v[128:131], v[76:79]
    v_mfma_f32_16x16x32_bf16 v[80:83], v[204:207], v[132:135], v[80:83]
    v_mfma_f32_16x16x32_bf16 v[84:87], v[204:207], v[136:139], v[84:87]
    v_mfma_f32_16x16x32_bf16 v[88:91], v[204:207], v[140:143], v[88:91]
    v_mfma_f32_16x16x32_bf16 v[92:95], v[204:207], v[144:147], v[92:95]
    v_mfma_f32_16x16x32_bf16 v[80:83], v[208:211], v[128:131], v[80:83]
    v_mfma_f32_16x16x32_bf16 v[84:87], v[208:211], v[132:135], v[84:87]
    v_mfma_f32_16x16x32_bf16 v[88:91], v[208:211], v[136:139], v[88:91]
    v_mfma_f32_16x16x32_bf16 v[92:95], v[208:211], v[140:143], v[92:95]
    v_mfma_f32_16x16x32_bf16 v[84:87], v[212:215], v[128:131], v[84:87]
    v_mfma_f32_16x16x32_bf16 v[88:91], v[212:215], v[132:135], v[88:91]
    v_mfma_f32_16x16x32_bf16 v[92:95], v[212:215], v[136:139], v[92:95]
    v_mfma_f32_16x16x32_bf16 v[88:91], v[216:219], v[128:131], v[88:91]
    v_mfma_f32_16x16x32_bf16 v[92:95], v[216:219], v[132:135], v[92:95]
    v_mfma_f32_16x16x32_bf16 v[92:95], v[220:223], v[128:131], v[92:95]
    s_waitcnt lgkmcnt(0)
    v_lshlrev_b32 v13, 5, v10
    v_lshrrev_b32 v15, 1, v11
    v_lshl_add_u32 v13, v15, 4, v13
    v_and_b32 v15, 1, v11
    v_sub_u32 v15, 1, v15
    v_lshl_add_u32 v13, v15, 3, v13
    v_add_u32 v13, 512, v13
    v_add_u32 v13, s64, v13
    ds_read_b64 v[96:97], v13 offset:0
    ds_read_b64 v[98:99], v13 offset:512
    ds_read_b64 v[100:101], v13 offset:1024
    ds_read_b64 v[102:103], v13 offset:1536
    ds_read_b64 v[104:105], v13 offset:2048
    ds_read_b64 v[106:107], v13 offset:2560
    ds_read_b64 v[108:109], v13 offset:3072
    ds_read_b64 v[110:111], v13 offset:3584
    v_lshlrev_b32 v14, 5, v10
    v_and_b32 v15, 2, v11
    v_lshl_add_u32 v14, v15, 3, v14
    v_and_b32 v15, 1, v11
    v_lshl_add_u32 v14, v15, 9, v14
    s_lshl_b32 s66, s62, 12
    s_add_u32 s66, s66, 17432576
    s_waitcnt lgkmcnt(0)
    v_and_b32 v16, 0xffff0000, v97
    v_lshlrev_b32 v17, 16, v97
    v_and_b32 v18, 0xffff0000, v96
    v_lshlrev_b32 v19, 16, v96
    v_fma_f32 v16, v16, v9, v64
    v_fma_f32 v17, v17, v9, v65
    v_fma_f32 v18, v18, v9, v66
    v_fma_f32 v19, v19, v9, v67
    v_cvt_pk_bf16_f32 v28, v16, v17
    v_cvt_pk_bf16_f32 v29, v18, v19
    v_and_b32 v16, 0xffff0000, v99
    v_lshlrev_b32 v17, 16, v99
    v_and_b32 v18, 0xffff0000, v98
    v_lshlrev_b32 v19, 16, v98
    v_fma_f32 v16, v16, v9, v68
    v_fma_f32 v17, v17, v9, v69
    v_fma_f32 v18, v18, v9, v70
    v_fma_f32 v19, v19, v9, v71
    v_cvt_pk_bf16_f32 v30, v16, v17
    v_cvt_pk_bf16_f32 v31, v18, v19
    s_nop 0
    v_permlane16_swap_b32 v28, v30
    v_permlane16_swap_b32 v29, v31
    buffer_store_dwordx4 v[28:31], v14, s[36:39], s66 offen offset:0 sc1
    v_and_b32 v16, 0xffff0000, v101
    v_lshlrev_b32 v17, 16, v101
    v_and_b32 v18, 0xffff0000, v100
    v_lshlrev_b32 v19, 16, v100
    v_fma_f32 v16, v16, v9, v72
    v_fma_f32 v17, v17, v9, v73
    v_fma_f32 v18, v18, v9, v74
    v_fma_f32 v19, v19, v9, v75
    v_cvt_pk_bf16_f32 v32, v16, v17
    v_cvt_pk_bf16_f32 v33, v18, v19
    v_and_b32 v16, 0xffff0000, v103
    v_lshlrev_b32 v17, 16, v103
    v_and_b32 v18, 0xffff0000, v102
    v_lshlrev_b32 v19, 16, v102
    v_fma_f32 v16, v16, v9, v76
    v_fma_f32 v17, v17, v9, v77
    v_fma_f32 v18, v18, v9, v78
    v_fma_f32 v19, v19, v9, v79
    v_cvt_pk_bf16_f32 v34, v16, v17
    v_cvt_pk_bf16_f32 v35, v18, v19
    s_nop 0
    v_permlane16_swap_b32 v32, v34
    v_permlane16_swap_b32 v33, v35
    buffer_store_dwordx4 v[32:35], v14, s[36:39], s66 offen offset:1024 sc1
    v_and_b32 v16, 0xffff0000, v105
    v_lshlrev_b32 v17, 16, v105
    v_and_b32 v18, 0xffff0000, v104
    v_lshlrev_b32 v19, 16, v104
    v_fma_f32 v16, v16, v9, v80
    v_fma_f32 v17, v17, v9, v81
    v_fma_f32 v18, v18, v9, v82
    v_fma_f32 v19, v19, v9, v83
    v_cvt_pk_bf16_f32 v28, v16, v17
    v_cvt_pk_bf16_f32 v29, v18, v19
    v_and_b32 v16, 0xffff0000, v107
    v_lshlrev_b32 v17, 16, v107
    v_and_b32 v18, 0xffff0000, v106
    v_lshlrev_b32 v19, 16, v106
    v_fma_f32 v16, v16, v9, v84
    v_fma_f32 v17, v17, v9, v85
    v_fma_f32 v18, v18, v9, v86
    v_fma_f32 v19, v19, v9, v87
    v_cvt_pk_bf16_f32 v30, v16, v17
    v_cvt_pk_bf16_f32 v31, v18, v19
    s_nop 0
    v_permlane16_swap_b32 v28, v30
    v_permlane16_swap_b32 v29, v31
    buffer_store_dwordx4 v[28:31], v14, s[36:39], s66 offen offset:2048 sc1
    v_and_b32 v16, 0xffff0000, v109
    v_lshlrev_b32 v17, 16, v109
    v_and_b32 v18, 0xffff0000, v108
    v_lshlrev_b32 v19, 16, v108
    v_fma_f32 v16, v16, v9, v88
    v_fma_f32 v17, v17, v9, v89
    v_fma_f32 v18, v18, v9, v90
    v_fma_f32 v19, v19, v9, v91
    v_cvt_pk_bf16_f32 v32, v16, v17
    v_cvt_pk_bf16_f32 v33, v18, v19
    v_and_b32 v16, 0xffff0000, v111
    v_lshlrev_b32 v17, 16, v111
    v_and_b32 v18, 0xffff0000, v110
    v_lshlrev_b32 v19, 16, v110
    v_fma_f32 v16, v16, v9, v92
    v_fma_f32 v17, v17, v9, v93
    v_fma_f32 v18, v18, v9, v94
    v_fma_f32 v19, v19, v9, v95
    v_cvt_pk_bf16_f32 v34, v16, v17
    v_cvt_pk_bf16_f32 v35, v18, v19
    s_nop 0
    v_permlane16_swap_b32 v32, v34
    v_permlane16_swap_b32 v33, v35
    buffer_store_dwordx4 v[32:35], v14, s[36:39], s66 offen offset:3072 sc1
    v_mov_b32 v4, 163748
    v_mov_b32 v5, 1
    s_mov_b64 exec, 1
    ds_add_u32 v4, v5
    s_mov_b64 exec, -1
    s_waitcnt vmcnt(0)
    s_and_b32 s65, s2, 7
    s_lshl_b32 s65, s65, 5
    s_lshr_b32 s66, s2, 3
    s_add_u32 s65, s65, s66
    s_lshl_b32 s65, s65, 7
    s_add_u32 s65, s65, 20152320
    v_mov_b32 v4, 163720
    v_mov_b32 v5, 1
    s_mov_b64 s[58:59], exec
    s_mov_b64 exec, 1
    ds_add_rtn_u32 v5, v4, v5
    s_waitcnt lgkmcnt(0)
    v_readfirstlane_b32 s56, v5
    s_nop 0
    s_add_u32 s56, s56, 1
    s_cmp_lg_u32 s56, s47
    s_cbranch_scc1 L_sig_62
    v_mov_b32 v4, 0
    v_mov_b32 v5, s41
    buffer_store_dword v5, v4, s[36:39], s65 offen sc1
L_sig_62:
    s_mov_b64 exec, s[58:59]
    s_branch L_fin_39
L_sync_52:
    s_mov_b32 s69, 0
    s_add_u32 m0, s69, s64
    s_nop 0
    buffer_load_dwordx4 v2, s[36:39], s48 offen sc1 lds
    s_add_u32 s48, s48, s53
    s_add_u32 m0, s69, s65
    s_nop 0
    buffer_load_dwordx4 v2, s[36:39], s49 offen sc1 lds
    s_add_u32 s49, s49, s54
    s_add_u32 m0, s69, s66
    s_nop 0
    buffer_load_dwordx4 v2, s[36:39], s50 offen sc1 lds
    s_add_u32 s50, s50, s55
    s_add_u32 m0, s69, s67
    s_nop 0
    buffer_load_dwordx4 v2, s[36:39], s51 offen sc1 lds
    s_add_u32 s51, s51, s62
    s_add_u32 m0, s69, s68
    s_nop 0
    buffer_load_dwordx4 v2, s[36:39], s52 offen sc1 lds
    s_add_u32 s52, s52, s63
    s_add_u32 s69, s69, 20480
    s_cmp_eq_u32 s69, 102400
    s_cselect_b32 s69, 0, s69
    s_add_u32 m0, s69, s64
    s_nop 0
    buffer_load_dwordx4 v2, s[36:39], s48 offen sc1 lds
    s_add_u32 s48, s48, s53
    s_add_u32 m0, s69, s65
    s_nop 0
    buffer_load_dwordx4 v2, s[36:39], s49 offen sc1 lds
    s_add_u32 s49, s49, s54
    s_add_u32 m0, s69, s66
    s_nop 0
    buffer_load_dwordx4 v2, s[36:39], s50 offen sc1 lds
    s_add_u32 s50, s50, s55
    s_add_u32 m0, s69, s67
    s_nop 0
    buffer_load_dwordx4 v2, s[36:39], s51 offen sc1 lds
    s_add_u32 s51, s51, s62
    s_add_u32 m0, s69, s68
    s_nop 0
    buffer_load_dwordx4 v2, s[36:39], s52 offen sc1 lds
    s_add_u32 s52, s52, s63
    s_add_u32 s69, s69, 20480
    s_cmp_eq_u32 s69, 102400
    s_cselect_b32 s69, 0, s69
    s_add_u32 m0, s69, s64
    s_nop 0
    buffer_load_dwordx4 v2, s[36:39], s48 offen sc1 lds
    s_add_u32 s48, s48, s53
    s_add_u32 m0, s69, s65
    s_nop 0
    buffer_load_dwordx4 v2, s[36:39], s49 offen sc1 lds
    s_add_u32 s49, s49, s54
    s_add_u32 m0, s69, s66
    s_nop 0
    buffer_load_dwordx4 v2, s[36:39], s50 offen sc1 lds
    s_add_u32 s50, s50, s55
    s_add_u32 m0, s69, s67
    s_nop 0
    buffer_load_dwordx4 v2, s[36:39], s51 offen sc1 lds
    s_add_u32 s51, s51, s62
    s_add_u32 m0, s69, s68
    s_nop 0
    buffer_load_dwordx4 v2, s[36:39], s52 offen sc1 lds
    s_add_u32 s52, s52, s63
    s_add_u32 s69, s69, 20480
    s_cmp_eq_u32 s69, 102400
    s_cselect_b32 s69, 0, s69
    s_barrier
    s_waitcnt vmcnt(5)
    s_barrier
    s_add_u32 m0, s69, s64
    s_nop 0
    buffer_load_dwordx4 v2, s[36:39], s48 offen sc1 lds
    s_add_u32 s48, s48, s53
    s_add_u32 m0, s69, s65
    s_nop 0
    buffer_load_dwordx4 v2, s[36:39], s49 offen sc1 lds
    s_add_u32 s49, s49, s54
    s_add_u32 m0, s69, s66
    s_nop 0
    buffer_load_dwordx4 v2, s[36:39], s50 offen sc1 lds
    s_add_u32 s50, s50, s55
    s_add_u32 m0, s69, s67
    s_nop 0
    buffer_load_dwordx4 v2, s[36:39], s51 offen sc1 lds
    s_add_u32 s51, s51, s62
    s_add_u32 m0, s69, s68
    s_nop 0
    buffer_load_dwordx4 v2, s[36:39], s52 offen sc1 lds
    s_add_u32 s52, s52, s63
    s_add_u32 s69, s69, 20480
    s_cmp_eq_u32 s69, 102400
    s_cselect_b32 s69, 0, s69
    s_add_u32 m0, s69, s64
    s_nop 0
    buffer_load_dwordx4 v2, s[36:39], s48 offen sc1 lds
    s_add_u32 s48, s48, s53
    s_add_u32 m0, s69, s65
    s_nop 0
    buffer_load_dwordx4 v2, s[36:39], s49 offen sc1 lds
    s_add_u32 s49, s49, s54
    s_add_u32 m0, s69, s66
    s_nop 0
    buffer_load_dwordx4 v2, s[36:39], s50 offen sc1 lds
    s_add_u32 s50, s50, s55
    s_add_u32 m0, s69, s67
    s_nop 0
    buffer_load_dwordx4 v2, s[36:39], s51 offen sc1 lds
    s_add_u32 s51, s51, s62
    s_add_u32 m0, s69, s68
    s_nop 0
    buffer_load_dwordx4 v2, s[36:39], s52 offen sc1 lds
    s_add_u32 s52, s52, s63
    s_add_u32 s69, s69, 20480
    s_cmp_eq_u32 s69, 102400
    s_cselect_b32 s69, 0, s69
    s_waitcnt vmcnt(10)
    s_barrier
    s_mov_b32 s61, 8
L_steady_63:
    s_add_u32 m0, s69, s64
    s_nop 0
    buffer_load_dwordx4 v2, s[36:39], s48 offen sc1 lds
    s_add_u32 s48, s48, s53
    s_add_u32 m0, s69, s65
    s_nop 0
    buffer_load_dwordx4 v2, s[36:39], s49 offen sc1 lds
    s_add_u32 s49, s49, s54
    s_add_u32 m0, s69, s66
    s_nop 0
    buffer_load_dwordx4 v2, s[36:39], s50 offen sc1 lds
    s_add_u32 s50, s50, s55
    s_add_u32 m0, s69, s67
    s_nop 0
    buffer_load_dwordx4 v2, s[36:39], s51 offen sc1 lds
    s_add_u32 s51, s51, s62
    s_add_u32 m0, s69, s68
    s_nop 0
    buffer_load_dwordx4 v2, s[36:39], s52 offen sc1 lds
    s_add_u32 s52, s52, s63
    s_add_u32 s69, s69, 20480
    s_cmp_eq_u32 s69, 102400
    s_cselect_b32 s69, 0, s69
    s_waitcnt vmcnt(10)
    s_barrier
    s_sub_u32 s61, s61, 1
    s_cmp_lg_u32 s61, 0
    s_cbranch_scc1 L_steady_63
    v_lshlrev_b32 v3, 7, v1
    s_mov_b32 s56, 20086784
    buffer_load_dword v4, v3, s[36:39], s56 offen sc1
    s_mov_b32 s56, 20094976
    buffer_load_dword v5, v3, s[36:39], s56 offen sc1
    s_mov_b32 s56, 20103168
    buffer_load_dword v6, v3, s[36:39], s56 offen sc1
    s_mov_b32 s56, 20111360
    buffer_load_dword v7, v3, s[36:39], s56 offen sc1
    s_add_u32 m0, s69, s64
    s_nop 0
    buffer_load_dwordx4 v2, s[36:39], s48 offen sc1 lds
    s_add_u32 s48, s48, s53
    s_add_u32 m0, s69, s65
    s_nop 0
    buffer_load_dwordx4 v2, s[36:39], s49 offen sc1 lds
    s_add_u32 s49, s49, s54
    s_add_u32 m0, s69, s66
    s_nop 0
    buffer_load_dwordx4 v2, s[36:39], s50 offen sc1 lds
    s_add_u32 s50, s50, s55
    s_add_u32 m0, s69, s67
    s_nop 0
    buffer_load_dwordx4 v2, s[36:39], s51 offen sc1 lds
    s_add_u32 s51, s51, s62
    s_add_u32 m0, s69, s68
    s_nop 0
    buffer_load_dwordx4 v2, s[36:39], s52 offen sc1 lds
    s_add_u32 s52, s52, s63
    s_add_u32 s69, s69, 20480
    s_cmp_eq_u32 s69, 102400
    s_cselect_b32 s69, 0, s69
    s_waitcnt vmcnt(14)
    s_barrier
    s_add_u32 m0, s69, s64
    s_nop 0
    buffer_load_dwordx4 v2, s[36:39], s48 offen sc1 lds
    s_add_u32 s48, s48, s53
    s_add_u32 m0, s69, s65
    s_nop 0
    buffer_load_dwordx4 v2, s[36:39], s49 offen sc1 lds
    s_add_u32 s49, s49, s54
    s_add_u32 m0, s69, s66
    s_nop 0
    buffer_load_dwordx4 v2, s[36:39], s50 offen sc1 lds
    s_add_u32 s50, s50, s55
    s_add_u32 m0, s69, s67
    s_nop 0
    buffer_load_dwordx4 v2, s[36:39], s51 offen sc1 lds
    s_add_u32 s51, s51, s62
    s_add_u32 m0, s69, s68
    s_nop 0
    buffer_load_dwordx4 v2, s[36:39], s52 offen sc1 lds
    s_add_u32 s52, s52, s63
    s_add_u32 s69, s69, 20480
    s_cmp_eq_u32 s69, 102400
    s_cselect_b32 s69, 0, s69
    s_waitcnt vmcnt(14)
    s_barrier
    s_add_u32 m0, s69, s64
    s_nop 0
    buffer_load_dwordx4 v2, s[36:39], s48 offen sc1 lds
    s_add_u32 s48, s48, s53
    s_add_u32 m0, s69, s65
    s_nop 0
    buffer_load_dwordx4 v2, s[36:39], s49 offen sc1 lds
    s_add_u32 s49, s49, s54
    s_add_u32 m0, s69, s66
    s_nop 0
    buffer_load_dwordx4 v2, s[36:39], s50 offen sc1 lds
    s_add_u32 s50, s50, s55
    s_add_u32 m0, s69, s67
    s_nop 0
    buffer_load_dwordx4 v2, s[36:39], s51 offen sc1 lds
    s_add_u32 s51, s51, s62
    s_add_u32 m0, s69, s68
    s_nop 0
    buffer_load_dwordx4 v2, s[36:39], s52 offen sc1 lds
    s_add_u32 s52, s52, s63
    s_add_u32 s69, s69, 20480
    s_cmp_eq_u32 s69, 102400
    s_cselect_b32 s69, 0, s69
    s_waitcnt vmcnt(10)
    s_barrier
    v_xor_b32 v4, s41, v4
    v_xor_b32 v5, s41, v5
    v_xor_b32 v6, s41, v6
    v_xor_b32 v7, s41, v7
    v_or_b32 v4, v4, v5
    v_or3_b32 v4, v4, v6, v7
    v_cmp_ne_u32 vcc, 0, v4
    s_nop 1
    s_cmp_eq_u64 vcc, 0
    s_cselect_b32 s95, 1, 0
    s_cbranch_scc0 L_all_64
    v_mov_b32 v8, 163724
    v_mov_b32 v9, 1
    ds_write_b32 v8, v9
L_all_64:
    s_mov_b32 s61, 4
L_steady_65:
    s_add_u32 m0, s69, s64
    s_nop 0
    buffer_load_dwordx4 v2, s[36:39], s48 offen sc1 lds
    s_add_u32 s48, s48, s53
    s_add_u32 m0, s69, s65
    s_nop 0
    buffer_load_dwordx4 v2, s[36:39], s49 offen sc1 lds
    s_add_u32 s49, s49, s54
    s_add_u32 m0, s69, s66
    s_nop 0
    buffer_load_dwordx4 v2, s[36:39], s50 offen sc1 lds
    s_add_u32 s50, s50, s55
    s_add_u32 m0, s69, s67
    s_nop 0
    buffer_load_dwordx4 v2, s[36:39], s51 offen sc1 lds
    s_add_u32 s51, s51, s62
    s_add_u32 m0, s69, s68
    s_nop 0
    buffer_load_dwordx4 v2, s[36:39], s52 offen sc1 lds
    s_add_u32 s52, s52, s63
    s_add_u32 s69, s69, 20480
    s_cmp_eq_u32 s69, 102400
    s_cselect_b32 s69, 0, s69
    s_waitcnt vmcnt(10)
    s_barrier
    s_sub_u32 s61, s61, 1
    s_cmp_lg_u32 s61, 0
    s_cbranch_scc1 L_steady_65
    s_cmp_eq_u32 s95, 1
    s_cbranch_scc1 L_all2_66
    s_mov_b32 s61, 20086784
    s_mov_b32 s57, 0
L_poll_67:
    buffer_load_dword v4, v3, s[36:39], s61 offen sc1
    s_add_u32 s56, s61, 8192
    buffer_load_dword v5, v3, s[36:39], s56 offen sc1
    s_add_u32 s56, s61, 16384
    buffer_load_dword v6, v3, s[36:39], s56 offen sc1
    s_add_u32 s56, s61, 24576
    buffer_load_dword v7, v3, s[36:39], s56 offen sc1
    s_waitcnt vmcnt(0)
    v_xor_b32 v4, s41, v4
    v_xor_b32 v5, s41, v5
    v_or_b32 v4, v4, v5
    v_xor_b32 v6, s41, v6
    v_or_b32 v4, v4, v6
    v_xor_b32 v7, s41, v7
    v_or_b32 v4, v4, v7
    v_cmp_ne_u32 vcc, 0, v4
    s_add_u32 s57, s57, 1
    s_cmp_gt_u32 s57, 65536
    s_cbranch_scc1 L_polld_68
    s_cmp_eq_u64 vcc, 0
    s_cbranch_scc0 L_poll_67
L_polld_68:
    v_mov_b32 v8, 163724
    v_mov_b32 v9, 1
    ds_write_b32 v8, v9
L_all2_66:
    s_bfe_u32 s56, s2, 0x30003
    s_mul_i32 s56, s56, 30720
    s_mul_i32 s57, s45, 245760
    s_add_u32 s56, s56, s57
    s_add_u32 s56, s56, 9175040
    buffer_load_dword v224, v3, s[36:39], s56 offen sc1
    s_add_u32 s56, s56, 8192
    buffer_load_dword v225, v3, s[36:39], s56 offen sc1
    s_add_u32 s56, s56, 8192
    buffer_load_dword v226, v3, s[36:39], s56 offen sc1
    s_add_u32 s56, s56, 8192
    s_mov_b64 s[58:59], exec
    s_mov_b32 exec_hi, 0x0000ffff
    buffer_load_dword v227, v3, s[36:39], s56 offen sc1
    s_mov_b64 exec, s[58:59]
    s_waitcnt vmcnt(9)
    s_barrier
    s_waitcnt vmcnt(4)
    s_barrier
    s_waitcnt vmcnt(4)
    s_barrier
    s_barrier
    s_cmp_eq_u32 s2, 0
    s_cbranch_scc0 L_ep_69
    v_mov_b32 v8, 0
    v_mov_b32 v9, s41
    s_mov_b32 s56, 20189184
    s_mov_b64 s[58:59], exec
    s_mov_b64 exec, 1
    buffer_store_dword v9, v8, s[36:39], s56 offen sc1
    s_mov_b64 exec, s[58:59]
L_ep_69:
    v_and_b32 v3, 15, v1
    v_lshlrev_b32 v3, 7, v3
    s_lshr_b32 s61, s44, 1
    s_lshl_b32 s61, s61, 11
    s_add_u32 s61, s61, 20119552
    s_mov_b32 s57, 0
L_poll_70:
    buffer_load_dword v4, v3, s[36:39], s61 offen sc1
    s_waitcnt vmcnt(0)
    v_xor_b32 v4, s41, v4
    v_cmp_ne_u32 vcc, 0, v4
    s_add_u32 s57, s57, 1
    s_cmp_gt_u32 s57, 65536
    s_cbranch_scc1 L_polld_71
    s_cmp_eq_u64 vcc, 0
    s_cbranch_scc0 L_poll_70
L_polld_71:
    v_mov_b32 v8, 163728
    v_mov_b32 v9, 1
    ds_write_b32 v8, v9
    v_and_b32 v3, 31, v1
    v_lshlrev_b32 v3, 7, v3
    s_lshl_b32 s61, s45, 12
    s_add_u32 s61, s61, 20152320
    s_mov_b32 s57, 0
L_poll_72:
    buffer_load_dword v4, v3, s[36:39], s61 offen sc1
    s_waitcnt vmcnt(0)
    v_xor_b32 v4, s41, v4
    v_cmp_ne_u32 vcc, 0, v4
    s_add_u32 s57, s57, 1
    s_cmp_gt_u32 s57, 65536
    s_cbranch_scc1 L_polld_73
    s_cmp_eq_u64 vcc, 0
    s_cbranch_scc0 L_poll_72
L_polld_73:
    v_lshrrev_b32 v3, 3, v1
    v_lshlrev_b32 v3, 12, v3
    v_and_b32 v4, 7, v1
    v_lshl_add_u32 v3, v4, 4, v3
    s_mul_i32 s60, s45, 80
    s_lshl_b32 s60, s60, 12
    s_lshl_b32 s61, s44, 7
    s_add_u32 s60, s60, s61
    s_add_u32 s60, s60, 17432576
    s_mov_b32 m0, 152320
    s_add_u32 s61, s60, 0
    buffer_load_dwordx4 v3, s[36:39], s61 offen sc1 lds
    s_mov_b32 m0, 153344
    s_add_u32 s61, s60, 32768
    buffer_load_dwordx4 v3, s[36:39], s61 offen sc1 lds
    s_mov_b32 m0, 154368
    s_add_u32 s61, s60, 65536
    buffer_load_dwordx4 v3, s[36:39], s61 offen sc1 lds
    s_mov_b32 m0, 155392
    s_add_u32 s61, s60, 98304
    buffer_load_dwordx4 v3, s[36:39], s61 offen sc1 lds
    s_mov_b32 m0, 156416
    s_add_u32 s61, s60, 131072
    buffer_load_dwordx4 v3, s[36:39], s61 offen sc1 lds
    s_mov_b32 m0, 157440
    s_add_u32 s61, s60, 163840
    buffer_load_dwordx4 v3, s[36:39], s61 offen sc1 lds
    s_mov_b32 m0, 158464
    s_add_u32 s61, s60, 196608
    buffer_load_dwordx4 v3, s[36:39], s61 offen sc1 lds
    s_mov_b32 m0, 159488
    s_add_u32 s61, s60, 229376
    buffer_load_dwordx4 v3, s[36:39], s61 offen sc1 lds
    s_mov_b32 m0, 160512
    s_add_u32 s61, s60, 262144
    buffer_load_dwordx4 v3, s[36:39], s61 offen sc1 lds
    s_mov_b32 m0, 161536
    s_add_u32 s61, s60, 294912
    buffer_load_dwordx4 v3, s[36:39], s61 offen sc1 lds
    s_waitcnt vmcnt(0)
    s_barrier
L_fin_39:
L_end:
    s_endpgm
.section .rodata,"a"
.p2align 6
.amdhsa_kernel parallel_sum__ssm_conv_s4__glu_gated_swiglu__prompt_kernel
  .amdhsa_next_free_vgpr 256
  .amdhsa_next_free_sgpr 100
  .amdhsa_accum_offset 256
  .amdhsa_group_segment_fixed_size 0
  .amdhsa_kernarg_size 128
  .amdhsa_user_sgpr_count 2
  .amdhsa_user_sgpr_kernarg_segment_ptr 1
  .amdhsa_system_sgpr_workgroup_id_x 1
.end_amdhsa_kernel
```
